```python
import torch

def _softmax(x, axis=-1):
    return torch.softmax(x, dim=axis)
def _gelu(x):
    return torch.nn.functional.gelu(x, approximate="tanh")
def _silu(x):
    return torch.nn.functional.silu(x)
def _sigmoid(x):
    return torch.sigmoid(x)
def _layernorm(x, axis=-1, eps=1e-5):
    m = x.mean(dim=axis, keepdim=True)
    v = x.var(dim=axis, keepdim=True, unbiased=False)
    return (x - m) / torch.sqrt(v + eps)
def _scatter_add(tgt, idx, src, axis=0):
    return tgt.clone().index_add_(axis, idx, src)
def _segment_sum(src, seg, n):
    out = torch.zeros((n,) + src.shape[1:], dtype=src.dtype)
    return out.index_add_(0, seg, src)
def _pad(x, pw):
    flat = tuple(v for pair in reversed(pw) for v in pair)
    return torch.nn.functional.pad(x, flat)

kernel_name = 'sequential_preLN__sliding_local_dilated__glu_gated_geglu__prompt'

def setup_inputs():

    _w = (lambda a: (lambda t: t.to(torch.bfloat16) if t.is_floating_point() else t)(torch.as_tensor(a)))
    def _A_setup():
        B, S, D = 1, 2048, 512
        return {
            "x": _w((lambda *s: torch.randn(*s, dtype=torch.bfloat16) * 0.05)(B, S, D)),
            "wqkv": _w((lambda *s: torch.randn(*s, dtype=torch.bfloat16) * 0.05)(D, 3 * D)),
            "wo": _w((lambda *s: torch.randn(*s, dtype=torch.bfloat16) * 0.05)(D, D)),
        }
    _A_in = _A_setup()

    def _B_setup():
        B, S, Dm, Df = 1, 2048, 512, 1376
        return {
            "x": _w((lambda *s: torch.randn(*s, dtype=torch.bfloat16) * 0.05)(B, S, Dm)),
            "w_gate": _w((lambda *s: torch.randn(*s, dtype=torch.bfloat16) * 0.8)(Dm, Df) * (Dm ** -0.5)),
            "w_up": _w((lambda *s: torch.randn(*s, dtype=torch.bfloat16) * 0.8)(Dm, Df) * (Dm ** -0.5)),
            "w_down": _w((lambda *s: torch.randn(*s, dtype=torch.bfloat16) * 0.8)(Df, Dm) * (Df ** -0.5)),
        }
    _B_in = _B_setup()

    return {
        "A_x": _A_in["x"],
        "A_wqkv": _A_in["wqkv"],
        "A_wo": _A_in["wo"],
        "B_x": _B_in["x"],
        "B_w_gate": _B_in["w_gate"],
        "B_w_up": _B_in["w_up"],
        "B_w_down": _B_in["w_down"],
    }

def reference(A_x, A_wqkv, A_wo, B_x, B_w_gate, B_w_up, B_w_down):
    def _A_ref(x, wqkv, wo):
        B, S, D = x.shape
        H = 32; Dh = D // H
        W, dil = 8, 2
        qkv = (lambda x, *d: x.permute(*d))((x @ wqkv).reshape(B, S, 3, H, Dh), 2, 0, 3, 1, 4)
        q, k, v = qkv[0], qkv[1], qkv[2]
        scale = Dh ** -0.5
        pos = torch.arange(S)
        off = torch.arange(W) * dil
        idx = pos[:, None] - off[None, :]
        mask = idx >= 0
        idx_c = torch.where(mask, idx, 0).reshape(-1)
        kg = k[:, :, idx_c, :].reshape(B, H, S, W, Dh)
        vg = v[:, :, idx_c, :].reshape(B, H, S, W, Dh)
        logits = torch.einsum("bhsd,bhswd->bhsw", q, kg) * scale
        logits = torch.where(mask[None, None, :, :], logits, -1e9)
        attn = _softmax(logits, axis=-1)
        o = torch.einsum("bhsw,bhswd->bhsd", attn, vg)
        return (lambda x, *d: x.permute(*d))(o, 0, 2, 1, 3).reshape(B, S, D) @ wo

    def _B_ref(x, w_gate, w_up, w_down):
        g = torch.einsum("bsd,df->bsf", x, w_gate)
        u = torch.einsum("bsd,df->bsf", x, w_up)
        h = _gelu(g) * u
        return torch.einsum("bsf,fd->bsd", h, w_down)

    x = A_x
    h = x + _A_ref(_layernorm(x, axis=-1), A_wqkv, A_wo)
    h2 = h + _B_ref(_layernorm(h, axis=-1), B_w_gate, B_w_up, B_w_down)
    return h2
```

```asm
; @launch grid=(256,1,1) block=(512,1,1) lds=163840
.amdgcn_target "amdgcn-amd-amdhsa--gfx950"
.text
.globl sequential_preLN__sliding_local_dilated__glu_gated_geglu__prompt_kernel
.p2align 8
.type sequential_preLN__sliding_local_dilated__glu_gated_geglu__prompt_kernel,@function
sequential_preLN__sliding_local_dilated__glu_gated_geglu__prompt_kernel:
    s_cmp_ge_u32 s2, 256
    s_cbranch_scc1 L_end
    s_load_dwordx16 s[48:63], s[0:1], 0
    s_load_dwordx4 s[64:67], s[0:1], 64
    s_memrealtime s[100:101]
    v_lshrrev_b32 v2, 6, v0
    v_and_b32 v1, 63, v0
    v_readfirstlane_b32 s3, v2
    s_and_b32 s4, s2, 7
    s_lshr_b32 s5, s2, 3
    s_lshl_b32 s6, s4, 2
    s_lshr_b32 s7, s5, 3
    s_add_u32 s45, s6, s7
    s_and_b32 s46, s5, 7
    s_and_b32 s44, s3, 3
    v_lshlrev_b32 v2, 4, v1
    s_cmp_lt_u32 s3, 4
    s_nop 0
    s_cbranch_scc1 L_compute
    s_cmp_ge_u32 s3, 6
    s_nop 0
    s_cbranch_scc1 L_job
    s_lshl_b32 s6, s44, 3
    v_lshrrev_b32 v11, 3, v1
    v_add_u32 v12, s6, v11
    v_bfe_u32 v13, v12, 1, 3
    v_and_b32 v14, 7, v1
    v_xor_b32 v13, v13, v14
    v_lshlrev_b32 v14, 10, v12
    v_lshl_add_u32 v14, v13, 4, v14
    v_mul_u32_u24 v11, 3072, v12
    v_bfe_u32 v12, v1, 4, 1
    s_lshl_b32 s6, s44, 1
    v_or_b32 v12, s6, v12
    v_bfe_u32 v13, v1, 1, 2
    v_xor_b32 v12, v12, v13
    v_and_b32 v13, 1, v1
    v_lshlrev_b32 v13, 4, v13
    v_lshl_add_u32 v12, v12, 5, v13
    s_lshl_b32 s7, s46, 7
    v_add3_u32 v15, v11, v12, s7
    s_lshl_b32 s74, s45, 16
    s_sub_u32 s75, s74, 16384
    s_max_i32 s75, s75, 0
    s_lshl_b32 s76, s44, 10
    s_mul_i32 s77, s44, 3072
    s_add_u32 s77, s77, 10240
    s_cmp_eq_u32 s44, 0
    s_cselect_b32 s78, 0xffffff00, -1
    s_add_u32 s6, s4, s46
    s_and_b32 s79, s6, 7
    s_mov_b32 s10, 2097152
    s_mov_b32 s11, 0x20000
    s_mov_b32 s14, 1572864
    s_mov_b32 s15, 0x20000
    s_waitcnt lgkmcnt(0)
    s_mov_b32 s8, s48
    s_and_b32 s9, s49, 0xffff
    s_mov_b32 s12, s50
    s_and_b32 s13, s51, 0xffff
    s_add_u32 s80, s79, 0
    s_and_b32 s80, s80, 7
    s_mul_i32 s81, s80, 196608
    s_lshl_b32 s80, s80, 7
    s_add_u32 m0, s76, 0
    s_add_u32 s3, s75, s80
    s_mov_b32 exec_lo, s78
    buffer_load_dwordx4 v14, s[8:11], s3 offen lds
    s_mov_b32 exec_lo, -1
    s_add_u32 m0, s76, 2048
    s_add_u32 s3, s74, s80
    buffer_load_dwordx4 v14, s[8:11], s3 offen lds
    s_add_u32 m0, s76, 4096
    s_add_u32 s3, s3, 16384
    buffer_load_dwordx4 v14, s[8:11], s3 offen lds
    s_add_u32 m0, s76, 6144
    s_add_u32 s3, s3, 16384
    buffer_load_dwordx4 v14, s[8:11], s3 offen lds
    s_add_u32 m0, s76, 8192
    s_add_u32 s3, s3, 16384
    buffer_load_dwordx4 v14, s[8:11], s3 offen lds
    s_add_u32 m0, s77, 0
    s_add_u32 s3, s81, 0
    buffer_load_dwordx4 v15, s[12:15], s3 offen offset:0 lds
    buffer_load_dwordx4 v15, s[12:15], s3 offen offset:1024 lds
    buffer_load_dwordx4 v15, s[12:15], s3 offen offset:2048 lds
    s_add_u32 m0, s77, 6144
    s_add_u32 s3, s81, 49152
    buffer_load_dwordx4 v15, s[12:15], s3 offen offset:0 lds
    buffer_load_dwordx4 v15, s[12:15], s3 offen offset:1024 lds
    buffer_load_dwordx4 v15, s[12:15], s3 offen offset:2048 lds
    s_add_u32 m0, s77, 12288
    s_add_u32 s3, s81, 98304
    buffer_load_dwordx4 v15, s[12:15], s3 offen offset:0 lds
    buffer_load_dwordx4 v15, s[12:15], s3 offen offset:1024 lds
    buffer_load_dwordx4 v15, s[12:15], s3 offen offset:2048 lds
    s_add_u32 m0, s77, 18432
    s_add_u32 s3, s81, 147456
    buffer_load_dwordx4 v15, s[12:15], s3 offen offset:0 lds
    buffer_load_dwordx4 v15, s[12:15], s3 offen offset:1024 lds
    buffer_load_dwordx4 v15, s[12:15], s3 offen offset:2048 lds
    s_lshl_b32 s4, s44, 2
    s_add_u32 s4, s4, 162816
    v_mov_b32 v7, s4
    v_mov_b32 v11, 0x40000
    v_cmp_eq_u32 vcc, 0, v1
    s_nop 1
    v_cndmask_b32 v6, v11, v7, vcc
    v_and_b32 v11, 3, v1
    v_lshlrev_b32 v11, 2, v11
    v_add_u32 v8, 162816, v11
    s_barrier
    ds_write_b32 v6, v6 offset:256
    ds_write_b32 v6, v6 offset:320
    s_add_u32 s80, s79, 1
    s_and_b32 s80, s80, 7
    s_mul_i32 s81, s80, 196608
    s_lshl_b32 s80, s80, 7
    s_add_u32 m0, s76, 34816
    s_add_u32 s3, s75, s80
    s_mov_b32 exec_lo, s78
    buffer_load_dwordx4 v14, s[8:11], s3 offen lds
    s_mov_b32 exec_lo, -1
    s_add_u32 m0, s76, 36864
    s_add_u32 s3, s74, s80
    buffer_load_dwordx4 v14, s[8:11], s3 offen lds
    s_add_u32 m0, s76, 38912
    s_add_u32 s3, s3, 16384
    buffer_load_dwordx4 v14, s[8:11], s3 offen lds
    s_add_u32 m0, s76, 40960
    s_add_u32 s3, s3, 16384
    buffer_load_dwordx4 v14, s[8:11], s3 offen lds
    s_add_u32 m0, s76, 43008
    s_add_u32 s3, s3, 16384
    buffer_load_dwordx4 v14, s[8:11], s3 offen lds
    s_add_u32 m0, s77, 34816
    s_add_u32 s3, s81, 0
    buffer_load_dwordx4 v15, s[12:15], s3 offen offset:0 lds
    buffer_load_dwordx4 v15, s[12:15], s3 offen offset:1024 lds
    buffer_load_dwordx4 v15, s[12:15], s3 offen offset:2048 lds
    s_add_u32 m0, s77, 40960
    s_add_u32 s3, s81, 49152
    buffer_load_dwordx4 v15, s[12:15], s3 offen offset:0 lds
    buffer_load_dwordx4 v15, s[12:15], s3 offen offset:1024 lds
    s_waitcnt vmcnt(16)
    ds_write_b32 v6, v6 offset:352
    buffer_load_dwordx4 v15, s[12:15], s3 offen offset:2048 lds
    s_add_u32 m0, s77, 47104
    s_add_u32 s3, s81, 98304
    buffer_load_dwordx4 v15, s[12:15], s3 offen offset:0 lds
    buffer_load_dwordx4 v15, s[12:15], s3 offen offset:1024 lds
    buffer_load_dwordx4 v15, s[12:15], s3 offen offset:2048 lds
    s_add_u32 m0, s77, 53248
    s_add_u32 s3, s81, 147456
    buffer_load_dwordx4 v15, s[12:15], s3 offen offset:0 lds
    buffer_load_dwordx4 v15, s[12:15], s3 offen offset:1024 lds
    s_waitcnt vmcnt(16)
    ds_write_b32 v6, v6 offset:368
    buffer_load_dwordx4 v15, s[12:15], s3 offen offset:2048 lds
    s_add_u32 s80, s79, 2
    s_and_b32 s80, s80, 7
    s_mul_i32 s81, s80, 196608
    s_lshl_b32 s80, s80, 7
    s_add_u32 m0, s76, 69632
    s_add_u32 s3, s75, s80
    s_mov_b32 exec_lo, s78
    buffer_load_dwordx4 v14, s[8:11], s3 offen lds
    s_mov_b32 exec_lo, -1
    s_add_u32 m0, s76, 71680
    s_add_u32 s3, s74, s80
    buffer_load_dwordx4 v14, s[8:11], s3 offen lds
    s_mov_b32 s16, s52
    s_and_b32 s17, s53, 0xffff
    s_mov_b32 s18, 524288
    s_mov_b32 s19, 0x20000
    s_mov_b32 s28, s60
    s_and_b32 s29, s61, 0xffff
    s_add_u32 m0, s76, 73728
    s_add_u32 s3, s3, 16384
    buffer_load_dwordx4 v14, s[8:11], s3 offen lds
    s_mov_b32 s30, 1409024
    s_mov_b32 s31, 0x20000
    s_mov_b32 s40, s66
    s_and_b32 s41, s67, 0xffff
    s_mov_b32 s42, 16777216
    s_mov_b32 s43, 0x20000
    s_add_u32 m0, s76, 75776
    s_add_u32 s3, s3, 16384
    buffer_load_dwordx4 v14, s[8:11], s3 offen lds
    s_and_b32 s4, s2, 7
    s_lshl_b32 s4, s4, 1
    s_lshr_b32 s6, s2, 7
    s_add_u32 s47, s4, s6
    s_lshr_b32 s4, s2, 3
    s_and_b32 s68, s4, 15
    s_add_u32 m0, s76, 77824
    s_add_u32 s3, s3, 16384
    buffer_load_dwordx4 v14, s[8:11], s3 offen lds
    s_mov_b32 s6, 0x7654e210
    s_mov_b32 s7, 0xb3dcfa98
    s_lshl_b32 s4, s68, 2
    s_lshr_b64 s[6:7], s[6:7], s4
    s_and_b32 s68, s6, 15
    v_bfe_u32 v11, v1, 4, 1
    s_add_u32 m0, s77, 69632
    s_add_u32 s3, s81, 0
    buffer_load_dwordx4 v15, s[12:15], s3 offen offset:0 lds
    v_lshlrev_b32 v11, 2, v11
    v_and_b32 v12, 7, v1
    v_xor_b32 v11, v11, v12
    v_lshlrev_b32 v11, 4, v11
    v_lshrrev_b32 v12, 3, v1
    v_lshl_add_u32 v11, v12, 10, v11
    buffer_load_dwordx4 v15, s[12:15], s3 offen offset:1024 lds
    s_lshl_b32 s4, s46, 7
    v_add_u32 v16, s4, v11
    s_lshl_b32 s6, s44, 14
    s_add_u32 s82, s6, 65536
    s_lshl_b32 s83, s44, 17
    s_lshl_b32 s88, s44, 12
    buffer_load_dwordx4 v15, s[12:15], s3 offen offset:2048 lds
    s_mul_i32 s4, s68, 196608
    s_add_u32 s4, s4, s88
    s_add_u32 s84, s4, 13631488
    s_cmp_ge_u32 s68, 14
    s_cselect_b32 s4, 0x80000000, 0
    v_or_b32 v18, s4, v2
    s_add_u32 m0, s77, 75776
    s_add_u32 s3, s81, 49152
    buffer_load_dwordx4 v15, s[12:15], s3 offen offset:0 lds
    s_cmp_eq_u32 s68, 15
    s_cselect_b32 s4, 0x80000000, 0
    s_cselect_b32 s6, 0, s68
    v_or_b32 v17, s4, v2
    s_lshl_b32 s6, s6, 3
    s_add_u32 s6, s6, s44
    buffer_load_dwordx4 v15, s[12:15], s3 offen offset:1024 lds
    s_lshl_b32 s7, s6, 9
    s_add_u32 s7, s7, 11403264
    v_and_b32 v11, 3, v1
    v_bfe_u32 v12, v1, 2, 1
    v_lshl_add_u32 v11, v12, 4, v11
    v_lshl_add_u32 v20, v11, 7, s7
    s_waitcnt vmcnt(16)
    ds_write_b32 v6, v6 offset:656
    buffer_load_dwordx4 v15, s[12:15], s3 offen offset:2048 lds
    s_lshl_b32 s6, s6, 12
    s_add_u32 s89, s6, 10764288
    v_mul_u32_u24 v21, 12, v1
    s_mul_i32 s4, s44, 6144
    s_add_u32 s4, s4, 131072
    v_add_u32 v22, s4, v2
    s_add_u32 m0, s77, 81920
    s_add_u32 s3, s81, 98304
    buffer_load_dwordx4 v15, s[12:15], s3 offen offset:0 lds
    s_mov_b32 s87, s4
    s_mul_i32 s4, s44, 16384
    s_add_u32 s4, s4, 65536
    v_add_u32 v23, s4, v2
    s_mul_i32 s4, s44, 16384
    s_add_u32 s4, s4, 0
    buffer_load_dwordx4 v15, s[12:15], s3 offen offset:1024 lds
    v_add_u32 v24, s4, v2
    s_lshr_b32 s4, s44, 1
    s_mul_i32 s4, s4, 6
    s_and_b32 s7, s44, 1
    s_add_u32 s4, s4, s7
    s_lshl_b32 s85, s4, 14
    buffer_load_dwordx4 v15, s[12:15], s3 offen offset:2048 lds
    s_lshl_b32 s86, s7, 14
    s_add_u32 m0, s77, 88064
    s_add_u32 s3, s81, 147456
    buffer_load_dwordx4 v15, s[12:15], s3 offen offset:0 lds
    buffer_load_dwordx4 v15, s[12:15], s3 offen offset:1024 lds
    s_waitcnt vmcnt(16)
    ds_write_b32 v6, v6 offset:384
    buffer_load_dwordx4 v15, s[12:15], s3 offen offset:2048 lds
    s_add_u32 s80, s79, 3
    s_and_b32 s80, s80, 7
    s_mul_i32 s81, s80, 196608
    s_lshl_b32 s80, s80, 7
    s_add_u32 m0, s76, 104448
    s_add_u32 s3, s75, s80
    s_mov_b32 exec_lo, s78
    buffer_load_dwordx4 v14, s[8:11], s3 offen lds
    s_mov_b32 exec_lo, -1
    s_add_u32 m0, s76, 106496
    s_add_u32 s3, s74, s80
    buffer_load_dwordx4 v14, s[8:11], s3 offen lds
    s_add_u32 m0, s76, 108544
    s_add_u32 s3, s3, 16384
    buffer_load_dwordx4 v14, s[8:11], s3 offen lds
    s_add_u32 m0, s76, 110592
    s_add_u32 s3, s3, 16384
    buffer_load_dwordx4 v14, s[8:11], s3 offen lds
    s_add_u32 m0, s76, 112640
    s_add_u32 s3, s3, 16384
    buffer_load_dwordx4 v14, s[8:11], s3 offen lds
    s_add_u32 m0, s77, 104448
    s_add_u32 s3, s81, 0
    buffer_load_dwordx4 v15, s[12:15], s3 offen offset:0 lds
    buffer_load_dwordx4 v15, s[12:15], s3 offen offset:1024 lds
    buffer_load_dwordx4 v15, s[12:15], s3 offen offset:2048 lds
    s_add_u32 m0, s77, 110592
    s_add_u32 s3, s81, 49152
    buffer_load_dwordx4 v15, s[12:15], s3 offen offset:0 lds
    buffer_load_dwordx4 v15, s[12:15], s3 offen offset:1024 lds
    s_waitcnt vmcnt(16)
    ds_write_b32 v6, v6 offset:672
    buffer_load_dwordx4 v15, s[12:15], s3 offen offset:2048 lds
    s_add_u32 m0, s77, 116736
    s_add_u32 s3, s81, 98304
    buffer_load_dwordx4 v15, s[12:15], s3 offen offset:0 lds
    buffer_load_dwordx4 v15, s[12:15], s3 offen offset:1024 lds
    buffer_load_dwordx4 v15, s[12:15], s3 offen offset:2048 lds
    ds_read_b32 v13, v8 offset:496
    s_add_u32 m0, s77, 122880
    s_add_u32 s3, s81, 147456
    buffer_load_dwordx4 v15, s[12:15], s3 offen offset:0 lds
    buffer_load_dwordx4 v15, s[12:15], s3 offen offset:1024 lds
    s_waitcnt vmcnt(16)
    ds_write_b32 v6, v6 offset:400
    buffer_load_dwordx4 v15, s[12:15], s3 offen offset:2048 lds
    s_waitcnt lgkmcnt(1)
    v_cmp_eq_u32 vcc, 0, v13
    s_nop 0
    s_cbranch_vccnz L_ls_1
L_lb_2:
    s_add_u32 s80, s79, 4
    s_and_b32 s80, s80, 7
    s_mul_i32 s81, s80, 196608
    s_lshl_b32 s80, s80, 7
    s_add_u32 m0, s76, 0
    s_add_u32 s3, s75, s80
    s_mov_b32 exec_lo, s78
    buffer_load_dwordx4 v14, s[8:11], s3 offen lds
    s_mov_b32 exec_lo, -1
    s_add_u32 m0, s76, 2048
    s_add_u32 s3, s74, s80
    buffer_load_dwordx4 v14, s[8:11], s3 offen lds
    s_add_u32 m0, s76, 4096
    s_add_u32 s3, s3, 16384
    buffer_load_dwordx4 v14, s[8:11], s3 offen lds
    s_add_u32 m0, s76, 6144
    s_add_u32 s3, s3, 16384
    buffer_load_dwordx4 v14, s[8:11], s3 offen lds
    s_add_u32 m0, s76, 8192
    s_add_u32 s3, s3, 16384
    buffer_load_dwordx4 v14, s[8:11], s3 offen lds
    s_add_u32 m0, s77, 0
    s_add_u32 s3, s81, 0
    buffer_load_dwordx4 v15, s[12:15], s3 offen offset:0 lds
    buffer_load_dwordx4 v15, s[12:15], s3 offen offset:1024 lds
    buffer_load_dwordx4 v15, s[12:15], s3 offen offset:2048 lds
    s_add_u32 m0, s77, 6144
    s_add_u32 s3, s81, 49152
    buffer_load_dwordx4 v15, s[12:15], s3 offen offset:0 lds
    buffer_load_dwordx4 v15, s[12:15], s3 offen offset:1024 lds
    buffer_load_dwordx4 v15, s[12:15], s3 offen offset:2048 lds
    s_add_u32 m0, s77, 12288
    s_add_u32 s3, s81, 98304
    buffer_load_dwordx4 v15, s[12:15], s3 offen offset:0 lds
    buffer_load_dwordx4 v15, s[12:15], s3 offen offset:1024 lds
    buffer_load_dwordx4 v15, s[12:15], s3 offen offset:2048 lds
    ds_read_b32 v13, v8 offset:512
    s_add_u32 m0, s77, 18432
    s_add_u32 s3, s81, 147456
    buffer_load_dwordx4 v15, s[12:15], s3 offen offset:0 lds
    buffer_load_dwordx4 v15, s[12:15], s3 offen offset:1024 lds
    s_waitcnt vmcnt(16)
    ds_write_b32 v6, v6 offset:416
    buffer_load_dwordx4 v15, s[12:15], s3 offen offset:2048 lds
    s_waitcnt lgkmcnt(1)
    v_cmp_eq_u32 vcc, 0, v13
    s_nop 0
    s_cbranch_vccnz L_ls_4
L_lb_5:
    s_add_u32 s80, s79, 5
    s_and_b32 s80, s80, 7
    s_mul_i32 s81, s80, 196608
    s_lshl_b32 s80, s80, 7
    s_add_u32 m0, s76, 34816
    s_add_u32 s3, s75, s80
    s_mov_b32 exec_lo, s78
    buffer_load_dwordx4 v14, s[8:11], s3 offen lds
    s_mov_b32 exec_lo, -1
    s_add_u32 m0, s76, 36864
    s_add_u32 s3, s74, s80
    buffer_load_dwordx4 v14, s[8:11], s3 offen lds
    s_add_u32 m0, s76, 38912
    s_add_u32 s3, s3, 16384
    buffer_load_dwordx4 v14, s[8:11], s3 offen lds
    s_add_u32 m0, s76, 40960
    s_add_u32 s3, s3, 16384
    buffer_load_dwordx4 v14, s[8:11], s3 offen lds
    s_add_u32 m0, s76, 43008
    s_add_u32 s3, s3, 16384
    buffer_load_dwordx4 v14, s[8:11], s3 offen lds
    s_add_u32 m0, s77, 34816
    s_add_u32 s3, s81, 0
    buffer_load_dwordx4 v15, s[12:15], s3 offen offset:0 lds
    buffer_load_dwordx4 v15, s[12:15], s3 offen offset:1024 lds
    buffer_load_dwordx4 v15, s[12:15], s3 offen offset:2048 lds
    s_add_u32 m0, s77, 40960
    s_add_u32 s3, s81, 49152
    buffer_load_dwordx4 v15, s[12:15], s3 offen offset:0 lds
    buffer_load_dwordx4 v15, s[12:15], s3 offen offset:1024 lds
    buffer_load_dwordx4 v15, s[12:15], s3 offen offset:2048 lds
    s_add_u32 m0, s77, 47104
    s_add_u32 s3, s81, 98304
    buffer_load_dwordx4 v15, s[12:15], s3 offen offset:0 lds
    buffer_load_dwordx4 v15, s[12:15], s3 offen offset:1024 lds
    buffer_load_dwordx4 v15, s[12:15], s3 offen offset:2048 lds
    ds_read_b32 v13, v8 offset:528
    s_add_u32 m0, s77, 53248
    s_add_u32 s3, s81, 147456
    buffer_load_dwordx4 v15, s[12:15], s3 offen offset:0 lds
    buffer_load_dwordx4 v15, s[12:15], s3 offen offset:1024 lds
    s_waitcnt vmcnt(16)
    ds_write_b32 v6, v6 offset:432
    buffer_load_dwordx4 v15, s[12:15], s3 offen offset:2048 lds
    s_waitcnt lgkmcnt(1)
    v_cmp_eq_u32 vcc, 0, v13
    s_nop 0
    s_cbranch_vccnz L_ls_7
L_lb_8:
    s_add_u32 s80, s79, 6
    s_and_b32 s80, s80, 7
    s_mul_i32 s81, s80, 196608
    s_lshl_b32 s80, s80, 7
    s_add_u32 m0, s76, 69632
    s_add_u32 s3, s75, s80
    s_mov_b32 exec_lo, s78
    buffer_load_dwordx4 v14, s[8:11], s3 offen lds
    s_mov_b32 exec_lo, -1
    s_add_u32 m0, s76, 71680
    s_add_u32 s3, s74, s80
    buffer_load_dwordx4 v14, s[8:11], s3 offen lds
    s_add_u32 m0, s76, 73728
    s_add_u32 s3, s3, 16384
    buffer_load_dwordx4 v14, s[8:11], s3 offen lds
    s_add_u32 m0, s76, 75776
    s_add_u32 s3, s3, 16384
    buffer_load_dwordx4 v14, s[8:11], s3 offen lds
    s_add_u32 m0, s76, 77824
    s_add_u32 s3, s3, 16384
    buffer_load_dwordx4 v14, s[8:11], s3 offen lds
    s_add_u32 m0, s77, 69632
    s_add_u32 s3, s81, 0
    buffer_load_dwordx4 v15, s[12:15], s3 offen offset:0 lds
    buffer_load_dwordx4 v15, s[12:15], s3 offen offset:1024 lds
    buffer_load_dwordx4 v15, s[12:15], s3 offen offset:2048 lds
    s_add_u32 m0, s77, 75776
    s_add_u32 s3, s81, 49152
    buffer_load_dwordx4 v15, s[12:15], s3 offen offset:0 lds
    buffer_load_dwordx4 v15, s[12:15], s3 offen offset:1024 lds
    buffer_load_dwordx4 v15, s[12:15], s3 offen offset:2048 lds
    s_add_u32 m0, s77, 81920
    s_add_u32 s3, s81, 98304
    buffer_load_dwordx4 v15, s[12:15], s3 offen offset:0 lds
    buffer_load_dwordx4 v15, s[12:15], s3 offen offset:1024 lds
    buffer_load_dwordx4 v15, s[12:15], s3 offen offset:2048 lds
    ds_read_b32 v13, v8 offset:544
    s_add_u32 m0, s77, 88064
    s_add_u32 s3, s81, 147456
    buffer_load_dwordx4 v15, s[12:15], s3 offen offset:0 lds
    buffer_load_dwordx4 v15, s[12:15], s3 offen offset:1024 lds
    s_waitcnt vmcnt(16)
    ds_write_b32 v6, v6 offset:448
    buffer_load_dwordx4 v15, s[12:15], s3 offen offset:2048 lds
    s_waitcnt lgkmcnt(1)
    v_cmp_eq_u32 vcc, 0, v13
    s_nop 0
    s_cbranch_vccnz L_ls_10
L_lb_11:
    s_add_u32 s80, s79, 7
    s_and_b32 s80, s80, 7
    s_mul_i32 s81, s80, 196608
    s_lshl_b32 s80, s80, 7
    s_add_u32 m0, s76, 104448
    s_add_u32 s3, s75, s80
    s_mov_b32 exec_lo, s78
    buffer_load_dwordx4 v14, s[8:11], s3 offen lds
    s_mov_b32 exec_lo, -1
    s_add_u32 m0, s76, 106496
    s_add_u32 s3, s74, s80
    buffer_load_dwordx4 v14, s[8:11], s3 offen lds
    s_add_u32 m0, s76, 108544
    s_add_u32 s3, s3, 16384
    buffer_load_dwordx4 v14, s[8:11], s3 offen lds
    s_add_u32 m0, s76, 110592
    s_add_u32 s3, s3, 16384
    buffer_load_dwordx4 v14, s[8:11], s3 offen lds
    s_add_u32 m0, s76, 112640
    s_add_u32 s3, s3, 16384
    buffer_load_dwordx4 v14, s[8:11], s3 offen lds
    s_add_u32 m0, s77, 104448
    s_add_u32 s3, s81, 0
    buffer_load_dwordx4 v15, s[12:15], s3 offen offset:0 lds
    buffer_load_dwordx4 v15, s[12:15], s3 offen offset:1024 lds
    buffer_load_dwordx4 v15, s[12:15], s3 offen offset:2048 lds
    s_add_u32 m0, s77, 110592
    s_add_u32 s3, s81, 49152
    buffer_load_dwordx4 v15, s[12:15], s3 offen offset:0 lds
    buffer_load_dwordx4 v15, s[12:15], s3 offen offset:1024 lds
    buffer_load_dwordx4 v15, s[12:15], s3 offen offset:2048 lds
    s_add_u32 m0, s77, 116736
    s_add_u32 s3, s81, 98304
    buffer_load_dwordx4 v15, s[12:15], s3 offen offset:0 lds
    buffer_load_dwordx4 v15, s[12:15], s3 offen offset:1024 lds
    buffer_load_dwordx4 v15, s[12:15], s3 offen offset:2048 lds
    s_add_u32 m0, s77, 122880
    s_add_u32 s3, s81, 147456
    buffer_load_dwordx4 v15, s[12:15], s3 offen offset:0 lds
    buffer_load_dwordx4 v15, s[12:15], s3 offen offset:1024 lds
    s_waitcnt vmcnt(16)
    ds_write_b32 v6, v6 offset:464
    buffer_load_dwordx4 v15, s[12:15], s3 offen offset:2048 lds
    ds_write_b32 v6, v6 offset:336
    s_waitcnt vmcnt(0)
    ds_write_b32 v6, v6 offset:480
    v_add_u32 v11, s82, v2
    s_mov_b32 s53, 0
    s_nop 0
L_lw_13:
    ds_read_b32 v13, v8 offset:240
    s_add_u32 s53, s53, 1
    s_cmp_gt_u32 s53, 1048576
    s_cbranch_scc1 L_lg_14
    s_sleep 1
    s_waitcnt lgkmcnt(0)
    v_cmp_eq_u32 vcc, 0, v13
    s_nop 0
    s_cbranch_vccnz L_lw_13
    s_nop 2
L_lg_14:
    s_add_u32 m0, s82, 0
    s_add_u32 s3, s83, 0
    buffer_load_dwordx4 v16, s[16:19], s3 offen lds
    s_add_u32 m0, s82, 1024
    s_add_u32 s3, s83, 8192
    buffer_load_dwordx4 v16, s[16:19], s3 offen lds
    s_add_u32 m0, s82, 2048
    s_add_u32 s3, s83, 16384
    buffer_load_dwordx4 v16, s[16:19], s3 offen lds
    s_add_u32 m0, s82, 3072
    s_add_u32 s3, s83, 24576
    buffer_load_dwordx4 v16, s[16:19], s3 offen lds
    s_add_u32 m0, s82, 4096
    s_add_u32 s3, s83, 32768
    buffer_load_dwordx4 v16, s[16:19], s3 offen lds
    s_add_u32 m0, s82, 5120
    s_add_u32 s3, s83, 40960
    buffer_load_dwordx4 v16, s[16:19], s3 offen lds
    s_add_u32 m0, s82, 6144
    s_add_u32 s3, s83, 49152
    buffer_load_dwordx4 v16, s[16:19], s3 offen lds
    s_add_u32 m0, s82, 7168
    s_add_u32 s3, s83, 57344
    buffer_load_dwordx4 v16, s[16:19], s3 offen lds
    s_add_u32 m0, s82, 8192
    s_add_u32 s3, s83, 65536
    buffer_load_dwordx4 v16, s[16:19], s3 offen lds
    s_add_u32 m0, s82, 9216
    s_add_u32 s3, s83, 73728
    buffer_load_dwordx4 v16, s[16:19], s3 offen lds
    s_add_u32 m0, s82, 10240
    s_add_u32 s3, s83, 81920
    buffer_load_dwordx4 v16, s[16:19], s3 offen lds
    s_add_u32 m0, s82, 11264
    s_add_u32 s3, s83, 90112
    buffer_load_dwordx4 v16, s[16:19], s3 offen lds
    s_add_u32 m0, s82, 12288
    s_add_u32 s3, s83, 98304
    buffer_load_dwordx4 v16, s[16:19], s3 offen lds
    s_add_u32 m0, s82, 13312
    s_add_u32 s3, s83, 106496
    buffer_load_dwordx4 v16, s[16:19], s3 offen lds
    s_add_u32 m0, s82, 14336
    s_add_u32 s3, s83, 114688
    buffer_load_dwordx4 v16, s[16:19], s3 offen lds
    s_add_u32 m0, s82, 15360
    s_add_u32 s3, s83, 122880
    buffer_load_dwordx4 v16, s[16:19], s3 offen lds
    s_add_u32 m0, s82, 32768
    s_add_u32 s3, s83, 262144
    buffer_load_dwordx4 v16, s[16:19], s3 offen lds
    s_add_u32 m0, s82, 33792
    s_add_u32 s3, s83, 270336
    buffer_load_dwordx4 v16, s[16:19], s3 offen lds
    s_add_u32 m0, s82, 34816
    s_add_u32 s3, s83, 278528
    buffer_load_dwordx4 v16, s[16:19], s3 offen lds
    s_add_u32 m0, s82, 35840
    s_add_u32 s3, s83, 286720
    buffer_load_dwordx4 v16, s[16:19], s3 offen lds
    s_add_u32 m0, s82, 36864
    s_add_u32 s3, s83, 294912
    buffer_load_dwordx4 v16, s[16:19], s3 offen lds
    s_add_u32 m0, s82, 37888
    s_add_u32 s3, s83, 303104
    buffer_load_dwordx4 v16, s[16:19], s3 offen lds
    s_add_u32 m0, s82, 38912
    s_add_u32 s3, s83, 311296
    buffer_load_dwordx4 v16, s[16:19], s3 offen lds
    s_add_u32 m0, s82, 39936
    s_add_u32 s3, s83, 319488
    buffer_load_dwordx4 v16, s[16:19], s3 offen lds
    s_add_u32 m0, s82, 40960
    s_add_u32 s3, s83, 327680
    buffer_load_dwordx4 v16, s[16:19], s3 offen lds
    s_add_u32 m0, s82, 41984
    s_add_u32 s3, s83, 335872
    buffer_load_dwordx4 v16, s[16:19], s3 offen lds
    s_add_u32 m0, s82, 43008
    s_add_u32 s3, s83, 344064
    buffer_load_dwordx4 v16, s[16:19], s3 offen lds
    s_add_u32 m0, s82, 44032
    s_add_u32 s3, s83, 352256
    buffer_load_dwordx4 v16, s[16:19], s3 offen lds
    s_add_u32 m0, s82, 45056
    s_add_u32 s3, s83, 360448
    buffer_load_dwordx4 v16, s[16:19], s3 offen lds
    s_add_u32 m0, s82, 46080
    s_add_u32 s3, s83, 368640
    buffer_load_dwordx4 v16, s[16:19], s3 offen lds
    s_add_u32 m0, s82, 47104
    s_add_u32 s3, s83, 376832
    buffer_load_dwordx4 v16, s[16:19], s3 offen lds
    s_add_u32 m0, s82, 48128
    s_add_u32 s3, s83, 385024
    buffer_load_dwordx4 v16, s[16:19], s3 offen lds
    s_waitcnt vmcnt(16)
    ds_write_b32 v6, v6 offset:0
    s_waitcnt vmcnt(0)
    ds_write_b32 v6, v6 offset:8
    s_mov_b32 s53, 0
    s_nop 0
L_lw_15:
    ds_read_b32 v13, v8 offset:256
    s_add_u32 s53, s53, 1
    s_cmp_gt_u32 s53, 1048576
    s_cbranch_scc1 L_lg_16
    s_waitcnt lgkmcnt(0)
    v_cmp_eq_u32 vcc, 0, v13
    s_nop 0
    s_cbranch_vccnz L_lw_15
    s_nop 2
L_lg_16:
    v_mov_b32 v11, 163824
    ds_read_b64 v[4:5], v11
    s_waitcnt lgkmcnt(0)
    v_readfirstlane_b32 s70, v4
    v_readfirstlane_b32 s71, v5
    s_nop 4
L_sym:
    s_setprio 0
    s_mov_b32 s53, 0
    s_nop 0
L_lw_25:
    ds_read_b32 v13, v8 offset:320
    s_add_u32 s53, s53, 1
    s_cmp_gt_u32 s53, 1048576
    s_cbranch_scc1 L_lg_26
    s_waitcnt lgkmcnt(0)
    v_cmp_eq_u32 vcc, 0, v13
    s_nop 0
    s_cbranch_vccnz L_lw_25
    s_nop 2
L_lg_26:
    s_add_u32 s3, s85, 622592
    buffer_load_dwordx4 v[28:31], v16, s[28:31], s3 offen
    s_waitcnt vmcnt(2)
    s_add_u32 s3, s85, 630784
    buffer_load_dwordx4 v[32:35], v16, s[28:31], s3 offen
    s_waitcnt vmcnt(2)
    s_add_u32 s3, s85, 819200
    buffer_load_dwordx4 v[36:39], v16, s[28:31], s3 offen
    s_waitcnt vmcnt(2)
    s_add_u32 s3, s85, 827392
    buffer_load_dwordx4 v[40:43], v16, s[28:31], s3 offen
    s_waitcnt vmcnt(2)
    s_add_u32 s3, s85, 1015808
    buffer_load_dwordx4 v[44:47], v16, s[28:31], s3 offen
    s_waitcnt vmcnt(2)
    s_add_u32 s3, s85, 1024000
    buffer_load_dwordx4 v[48:51], v16, s[28:31], s3 offen
    s_waitcnt vmcnt(2)
    s_add_u32 s3, s85, 1212416
    buffer_load_dwordx4 v[52:55], v16, s[28:31], s3 offen
    s_waitcnt vmcnt(2)
    s_add_u32 s3, s85, 1220608
    buffer_load_dwordx4 v[56:59], v16, s[28:31], s3 offen
    s_waitcnt vmcnt(2)
    s_add_u32 s3, s85, 65536
    buffer_load_dwordx4 v[60:63], v16, s[28:31], s3 offen
    s_waitcnt vmcnt(2)
    s_add_u32 s3, s85, 73728
    buffer_load_dwordx4 v[64:67], v16, s[28:31], s3 offen
    s_waitcnt vmcnt(2)
    s_add_u32 s3, s85, 262144
    buffer_load_dwordx4 v[68:71], v16, s[28:31], s3 offen
    s_waitcnt vmcnt(2)
    s_add_u32 s3, s85, 270336
    buffer_load_dwordx4 v[72:75], v16, s[28:31], s3 offen
    s_waitcnt vmcnt(2)
    buffer_load_dwordx2 v[26:27], v20, s[40:43], 0 offen offset:0 sc1
    s_mov_b32 s53, 0
    s_nop 0
L_lw_27:
    ds_read_b32 v13, v8 offset:560
    s_add_u32 s53, s53, 1
    s_cmp_gt_u32 s53, 1048576
    s_cbranch_scc1 L_lg_28
    s_sleep 1
    s_waitcnt lgkmcnt(0)
    v_cmp_eq_u32 vcc, 0, v13
    s_nop 0
    s_cbranch_vccnz L_lw_27
    s_nop 2
L_lg_28:
    s_waitcnt vmcnt(0)
    v_cmp_ne_u64 vcc, s[70:71], v[26:27]
    s_nop 0
    s_cbranch_vccnz L_as_29
L_ab_30:
    s_add_u32 m0, s88, 16384
    s_add_u32 s3, s84, 16384
    buffer_load_dwordx4 v17, s[40:43], s3 offen offset:0 sc1 lds
    s_waitcnt vmcnt(8)
    buffer_load_dwordx4 v17, s[40:43], s3 offen offset:1024 sc1 lds
    s_waitcnt vmcnt(8)
    buffer_load_dwordx4 v17, s[40:43], s3 offen offset:2048 sc1 lds
    s_waitcnt vmcnt(8)
    buffer_load_dwordx4 v17, s[40:43], s3 offen offset:3072 sc1 lds
    s_waitcnt vmcnt(8)
    s_add_u32 m0, s88, 49152
    s_add_u32 s3, s84, 49152
    buffer_load_dwordx4 v17, s[40:43], s3 offen offset:0 sc1 lds
    s_waitcnt vmcnt(8)
    buffer_load_dwordx4 v17, s[40:43], s3 offen offset:1024 sc1 lds
    s_waitcnt vmcnt(8)
    buffer_load_dwordx4 v17, s[40:43], s3 offen offset:2048 sc1 lds
    s_waitcnt vmcnt(8)
    buffer_load_dwordx4 v17, s[40:43], s3 offen offset:3072 sc1 lds
    s_waitcnt vmcnt(8)
    s_waitcnt vmcnt(0)
    ds_write_b32 v6, v6 offset:64
    s_mov_b32 s53, 0
    s_nop 0
L_lw_32:
    ds_read_b32 v13, v8 offset:48
    s_add_u32 s53, s53, 1
    s_cmp_gt_u32 s53, 1048576
    s_cbranch_scc1 L_lg_33
    s_sleep 1
    s_waitcnt lgkmcnt(0)
    v_cmp_eq_u32 vcc, 0, v13
    s_nop 0
    s_cbranch_vccnz L_lw_32
    s_nop 2
L_lg_33:
    s_add_u32 m0, s88, 81920
    s_add_u32 s3, s84, 81920
    buffer_load_dwordx4 v18, s[40:43], s3 offen offset:0 sc1 lds
    s_waitcnt vmcnt(8)
    buffer_load_dwordx4 v18, s[40:43], s3 offen offset:1024 sc1 lds
    s_waitcnt vmcnt(8)
    buffer_load_dwordx4 v18, s[40:43], s3 offen offset:2048 sc1 lds
    s_waitcnt vmcnt(8)
    buffer_load_dwordx4 v18, s[40:43], s3 offen offset:3072 sc1 lds
    s_waitcnt vmcnt(8)
    s_add_u32 m0, s88, 114688
    s_add_u32 s3, s84, 114688
    buffer_load_dwordx4 v18, s[40:43], s3 offen offset:0 sc1 lds
    s_waitcnt vmcnt(8)
    buffer_load_dwordx4 v18, s[40:43], s3 offen offset:1024 sc1 lds
    s_waitcnt vmcnt(8)
    buffer_load_dwordx4 v18, s[40:43], s3 offen offset:2048 sc1 lds
    s_waitcnt vmcnt(8)
    buffer_load_dwordx4 v18, s[40:43], s3 offen offset:3072 sc1 lds
    s_waitcnt vmcnt(8)
    s_waitcnt vmcnt(0)
    ds_write_b32 v6, v6 offset:80
    s_mov_b32 s53, 0
    s_nop 0
L_lw_34:
    ds_read_b32 v13, v8 offset:576
    s_add_u32 s53, s53, 1
    s_cmp_gt_u32 s53, 1048576
    s_cbranch_scc1 L_lg_35
    s_sleep 1
    s_waitcnt lgkmcnt(0)
    v_cmp_eq_u32 vcc, 0, v13
    s_nop 0
    s_cbranch_vccnz L_lw_34
    s_nop 2
L_lg_35:
    s_add_u32 m0, s88, 0
    s_add_u32 s3, s84, 0
    buffer_load_dwordx4 v17, s[40:43], s3 offen offset:0 sc1 lds
    s_waitcnt vmcnt(8)
    buffer_load_dwordx4 v17, s[40:43], s3 offen offset:1024 sc1 lds
    s_waitcnt vmcnt(8)
    buffer_load_dwordx4 v17, s[40:43], s3 offen offset:2048 sc1 lds
    s_waitcnt vmcnt(8)
    buffer_load_dwordx4 v17, s[40:43], s3 offen offset:3072 sc1 lds
    s_waitcnt vmcnt(8)
    s_add_u32 m0, s88, 32768
    s_add_u32 s3, s84, 32768
    buffer_load_dwordx4 v17, s[40:43], s3 offen offset:0 sc1 lds
    s_waitcnt vmcnt(8)
    buffer_load_dwordx4 v17, s[40:43], s3 offen offset:1024 sc1 lds
    s_waitcnt vmcnt(8)
    buffer_load_dwordx4 v17, s[40:43], s3 offen offset:2048 sc1 lds
    s_waitcnt vmcnt(8)
    buffer_load_dwordx4 v17, s[40:43], s3 offen offset:3072 sc1 lds
    s_waitcnt vmcnt(8)
    s_add_u32 s3, s89, 0
    buffer_load_dwordx3 v[204:206], v21, s[40:43], s3 offen offset:0 sc1
    s_waitcnt vmcnt(8)
    s_add_u32 s3, s89, 0
    buffer_load_dwordx3 v[208:210], v21, s[40:43], s3 offen offset:1024 sc1
    s_waitcnt vmcnt(8)
    s_add_u32 s3, s89, 0
    buffer_load_dwordx3 v[212:214], v21, s[40:43], s3 offen offset:2048 sc1
    s_waitcnt vmcnt(8)
    s_add_u32 s3, s89, 0
    buffer_load_dwordx3 v[216:218], v21, s[40:43], s3 offen offset:3072 sc1
    s_waitcnt vmcnt(8)
    s_add_u32 s3, s89, 16384
    buffer_load_dwordx3 v[220:222], v21, s[40:43], s3 offen offset:0 sc1
    s_waitcnt vmcnt(8)
    s_add_u32 s3, s89, 16384
    buffer_load_dwordx3 v[224:226], v21, s[40:43], s3 offen offset:1024 sc1
    s_waitcnt vmcnt(8)
    s_waitcnt vmcnt(6)
    ds_write_b32 v6, v6 offset:640
    s_add_u32 s3, s89, 16384
    buffer_load_dwordx3 v[228:230], v21, s[40:43], s3 offen offset:2048 sc1
    s_waitcnt vmcnt(8)
    s_add_u32 s3, s89, 16384
    buffer_load_dwordx3 v[232:234], v21, s[40:43], s3 offen offset:3072 sc1
    s_waitcnt vmcnt(8)
    s_add_u32 m0, s88, 65536
    s_add_u32 s3, s84, 65536
    buffer_load_dwordx4 v18, s[40:43], s3 offen offset:0 sc1 lds
    s_waitcnt vmcnt(8)
    buffer_load_dwordx4 v18, s[40:43], s3 offen offset:1024 sc1 lds
    s_waitcnt vmcnt(8)
    buffer_load_dwordx4 v18, s[40:43], s3 offen offset:2048 sc1 lds
    s_waitcnt vmcnt(8)
    buffer_load_dwordx4 v18, s[40:43], s3 offen offset:3072 sc1 lds
    s_waitcnt vmcnt(8)
    s_add_u32 m0, s88, 98304
    s_add_u32 s3, s84, 98304
    buffer_load_dwordx4 v18, s[40:43], s3 offen offset:0 sc1 lds
    s_waitcnt vmcnt(8)
    buffer_load_dwordx4 v18, s[40:43], s3 offen offset:1024 sc1 lds
    s_waitcnt vmcnt(8)
    buffer_load_dwordx4 v18, s[40:43], s3 offen offset:2048 sc1 lds
    s_waitcnt vmcnt(8)
    buffer_load_dwordx4 v18, s[40:43], s3 offen offset:3072 sc1 lds
    s_waitcnt vmcnt(8)
    v_add_f32 v204, v204, v220
    v_add_f32 v205, v205, v221
    v_add_f32 v206, v206, v222
    v_add_f32 v208, v208, v224
    v_add_f32 v209, v209, v225
    v_add_f32 v210, v210, v226
    v_add_f32 v212, v212, v228
    v_add_f32 v213, v213, v229
    v_add_f32 v214, v214, v230
    v_add_f32 v216, v216, v232
    v_add_f32 v217, v217, v233
    v_add_f32 v218, v218, v234
    v_add_f32 v204, v204, v212
    v_add_f32 v205, v205, v213
    v_add_f32 v206, v206, v214
    v_add_f32 v208, v208, v216
    v_add_f32 v209, v209, v217
    v_add_f32 v210, v210, v218
    v_add_f32 v204, v204, v208
    v_add_f32 v205, v205, v209
    v_add_f32 v206, v206, v210
    s_lshr_b32 s4, s44, 1
    s_lshl_b32 s4, s4, 9
    s_and_b32 s6, s44, 1
    s_lshl_b32 s6, s6, 3
    s_add_u32 s4, s4, s6
    s_add_u32 s4, s4, 155648
    v_and_b32 v12, 31, v1
    v_lshl_add_u32 v11, v12, 4, s4
    v_lshrrev_b32 v12, 5, v1
    v_lshl_add_u32 v11, v12, 10, v11
    s_mov_b32 s53, 0
    s_nop 0
L_lw_36:
    ds_read_b32 v13, v8 offset:304
    s_add_u32 s53, s53, 1
    s_cmp_gt_u32 s53, 1048576
    s_cbranch_scc1 L_lg_37
    s_sleep 1
    s_waitcnt lgkmcnt(0)
    v_cmp_eq_u32 vcc, 0, v13
    s_nop 0
    s_cbranch_vccnz L_lw_36
    s_nop 2
L_lg_37:
    v_cvt_pk_bf16_f32 v237, v204, 0
    v_lshlrev_b32 v12, 16, v237
    v_sub_f32 v12, v204, v12
    v_cvt_pk_bf16_f32 v236, v204, v12
    ds_write_b64 v11, v[236:237] offset:0
    v_cvt_pk_bf16_f32 v239, v205, 0
    v_lshlrev_b32 v12, 16, v239
    v_sub_f32 v12, v205, v12
    v_cvt_pk_bf16_f32 v238, v205, v12
    ds_write_b64 v11, v[238:239] offset:2048
    v_cvt_pk_bf16_f32 v241, v206, 0
    v_lshlrev_b32 v12, 16, v241
    v_sub_f32 v12, v206, v12
    v_cvt_pk_bf16_f32 v240, v206, v12
    ds_write_b64 v11, v[240:241] offset:4096
    ds_write_b32 v6, v6 offset:288
    s_add_u32 s3, s85, 458752
    buffer_load_dwordx4 v[76:79], v16, s[28:31], s3 offen
    s_waitcnt vmcnt(8)
    s_add_u32 s3, s85, 466944
    buffer_load_dwordx4 v[80:83], v16, s[28:31], s3 offen
    s_waitcnt vmcnt(8)
    s_add_u32 s3, s85, 655360
    buffer_load_dwordx4 v[84:87], v16, s[28:31], s3 offen
    s_waitcnt vmcnt(8)
    s_add_u32 s3, s85, 663552
    buffer_load_dwordx4 v[88:91], v16, s[28:31], s3 offen
    s_waitcnt vmcnt(8)
    s_waitcnt vmcnt(4)
    ds_write_b32 v6, v6 offset:592
    s_mov_b32 s53, 0
    s_nop 0
L_lw_38:
    ds_read_b32 v13, v8 offset:96
    s_add_u32 s53, s53, 1
    s_cmp_gt_u32 s53, 1048576
    s_cbranch_scc1 L_lg_39
    s_sleep 1
    s_waitcnt lgkmcnt(0)
    v_cmp_eq_u32 vcc, 0, v13
    s_nop 0
    s_cbranch_vccnz L_lw_38
    s_nop 2
L_lg_39:
    s_add_u32 m0, s88, 16384
    s_add_u32 s3, s84, 147456
    buffer_load_dwordx4 v18, s[40:43], s3 offen offset:0 sc1 lds
    s_waitcnt vmcnt(8)
    buffer_load_dwordx4 v18, s[40:43], s3 offen offset:1024 sc1 lds
    s_waitcnt vmcnt(8)
    buffer_load_dwordx4 v18, s[40:43], s3 offen offset:2048 sc1 lds
    s_waitcnt vmcnt(8)
    buffer_load_dwordx4 v18, s[40:43], s3 offen offset:3072 sc1 lds
    s_waitcnt vmcnt(8)
    s_add_u32 m0, s88, 49152
    s_add_u32 s3, s84, 180224
    buffer_load_dwordx4 v18, s[40:43], s3 offen offset:0 sc1 lds
    s_waitcnt vmcnt(8)
    buffer_load_dwordx4 v18, s[40:43], s3 offen offset:1024 sc1 lds
    s_waitcnt vmcnt(8)
    buffer_load_dwordx4 v18, s[40:43], s3 offen offset:2048 sc1 lds
    s_waitcnt vmcnt(8)
    buffer_load_dwordx4 v18, s[40:43], s3 offen offset:3072 sc1 lds
    s_waitcnt vmcnt(8)
    s_add_u32 s3, s85, 851968
    buffer_load_dwordx4 v[92:95], v16, s[28:31], s3 offen
    s_waitcnt vmcnt(8)
    s_add_u32 s3, s85, 860160
    buffer_load_dwordx4 v[96:99], v16, s[28:31], s3 offen
    s_waitcnt vmcnt(8)
    s_add_u32 s3, s85, 1048576
    buffer_load_dwordx4 v[100:103], v16, s[28:31], s3 offen
    s_waitcnt vmcnt(8)
    s_add_u32 s3, s85, 1056768
    buffer_load_dwordx4 v[104:107], v16, s[28:31], s3 offen
    s_waitcnt vmcnt(8)
    s_add_u32 s3, s85, 1245184
    buffer_load_dwordx4 v[108:111], v16, s[28:31], s3 offen
    s_waitcnt vmcnt(8)
    s_add_u32 s3, s85, 1253376
    buffer_load_dwordx4 v[112:115], v16, s[28:31], s3 offen
    s_waitcnt vmcnt(8)
    s_waitcnt vmcnt(6)
    ds_write_b32 v6, v6 offset:112
    s_mov_b32 s53, 0
    s_nop 0
L_lw_40:
    ds_read_b32 v13, v8 offset:624
    s_add_u32 s53, s53, 1
    s_cmp_gt_u32 s53, 1048576
    s_cbranch_scc1 L_lg_41
    s_sleep 1
    s_waitcnt lgkmcnt(0)
    v_cmp_eq_u32 vcc, 0, v13
    s_nop 0
    s_cbranch_vccnz L_lw_40
    s_nop 2
L_lg_41:
    s_add_u32 m0, s88, 0
    s_add_u32 s3, s84, 131072
    buffer_load_dwordx4 v18, s[40:43], s3 offen offset:0 sc1 lds
    s_waitcnt vmcnt(8)
    buffer_load_dwordx4 v18, s[40:43], s3 offen offset:1024 sc1 lds
    s_waitcnt vmcnt(8)
    buffer_load_dwordx4 v18, s[40:43], s3 offen offset:2048 sc1 lds
    s_waitcnt vmcnt(8)
    buffer_load_dwordx4 v18, s[40:43], s3 offen offset:3072 sc1 lds
    s_waitcnt vmcnt(8)
    s_add_u32 m0, s88, 32768
    s_add_u32 s3, s84, 163840
    buffer_load_dwordx4 v18, s[40:43], s3 offen offset:0 sc1 lds
    s_waitcnt vmcnt(8)
    buffer_load_dwordx4 v18, s[40:43], s3 offen offset:1024 sc1 lds
    s_waitcnt vmcnt(8)
    buffer_load_dwordx4 v18, s[40:43], s3 offen offset:2048 sc1 lds
    s_waitcnt vmcnt(8)
    buffer_load_dwordx4 v18, s[40:43], s3 offen offset:3072 sc1 lds
    s_waitcnt vmcnt(8)
    s_add_u32 m0, s87, 0
    s_add_u32 s3, s85, 0
    buffer_load_dwordx4 v16, s[28:31], s3 offen lds
    s_waitcnt vmcnt(8)
    s_add_u32 m0, s87, 1024
    s_add_u32 s3, s85, 8192
    buffer_load_dwordx4 v16, s[28:31], s3 offen lds
    s_waitcnt vmcnt(8)
    s_add_u32 m0, s87, 2048
    s_add_u32 s3, s85, 196608
    buffer_load_dwordx4 v16, s[28:31], s3 offen lds
    s_waitcnt vmcnt(8)
    s_add_u32 m0, s87, 3072
    s_add_u32 s3, s85, 204800
    buffer_load_dwordx4 v16, s[28:31], s3 offen lds
    s_waitcnt vmcnt(8)
    s_add_u32 m0, s87, 4096
    s_add_u32 s3, s85, 393216
    buffer_load_dwordx4 v16, s[28:31], s3 offen lds
    s_waitcnt vmcnt(8)
    s_add_u32 m0, s87, 5120
    s_add_u32 s3, s85, 401408
    buffer_load_dwordx4 v16, s[28:31], s3 offen lds
    s_waitcnt vmcnt(8)
    s_waitcnt vmcnt(6)
    ds_write_b32 v6, v6 offset:608
    s_waitcnt vmcnt(0)
    ds_write_b32 v6, v6 offset:160
    s_mov_b32 s53, 0
    s_nop 0
L_lw_42:
    ds_read_b32 v13, v8 offset:128
    s_add_u32 s53, s53, 1
    s_cmp_gt_u32 s53, 1048576
    s_cbranch_scc1 L_lg_43
    s_sleep 1
    s_waitcnt lgkmcnt(0)
    v_cmp_eq_u32 vcc, 0, v13
    s_nop 0
    s_cbranch_vccnz L_lw_42
    s_nop 2
L_lg_43:
    s_add_u32 m0, s82, 0
    s_add_u32 s3, s85, 589824
    buffer_load_dwordx4 v16, s[28:31], s3 offen lds
    s_waitcnt vmcnt(8)
    s_add_u32 m0, s82, 1024
    s_add_u32 s3, s85, 598016
    buffer_load_dwordx4 v16, s[28:31], s3 offen lds
    s_waitcnt vmcnt(8)
    s_add_u32 m0, s82, 2048
    s_add_u32 s3, s85, 786432
    buffer_load_dwordx4 v16, s[28:31], s3 offen lds
    s_waitcnt vmcnt(8)
    s_add_u32 m0, s82, 3072
    s_add_u32 s3, s85, 794624
    buffer_load_dwordx4 v16, s[28:31], s3 offen lds
    s_waitcnt vmcnt(8)
    s_add_u32 m0, s82, 4096
    s_add_u32 s3, s85, 983040
    buffer_load_dwordx4 v16, s[28:31], s3 offen lds
    s_waitcnt vmcnt(8)
    s_add_u32 m0, s82, 5120
    s_add_u32 s3, s85, 991232
    buffer_load_dwordx4 v16, s[28:31], s3 offen lds
    s_waitcnt vmcnt(8)
    s_add_u32 m0, s82, 6144
    s_add_u32 s3, s85, 1179648
    buffer_load_dwordx4 v16, s[28:31], s3 offen lds
    s_waitcnt vmcnt(8)
    s_add_u32 m0, s82, 7168
    s_add_u32 s3, s85, 1187840
    buffer_load_dwordx4 v16, s[28:31], s3 offen lds
    s_waitcnt vmcnt(8)
    s_add_u32 m0, s82, 8192
    s_add_u32 s3, s86, 1376256
    buffer_load_dwordx4 v16, s[28:31], s3 offen lds
    s_waitcnt vmcnt(8)
    s_add_u32 m0, s82, 9216
    s_add_u32 s3, s86, 1384448
    buffer_load_dwordx4 v16, s[28:31], s3 offen lds
    s_waitcnt vmcnt(8)
    s_add_u32 m0, s82, 10240
    s_add_u32 s3, s85, 32768
    buffer_load_dwordx4 v16, s[28:31], s3 offen lds
    s_waitcnt vmcnt(8)
    s_add_u32 m0, s82, 11264
    s_add_u32 s3, s85, 40960
    buffer_load_dwordx4 v16, s[28:31], s3 offen lds
    s_waitcnt vmcnt(8)
    s_add_u32 m0, s82, 12288
    s_add_u32 s3, s85, 229376
    buffer_load_dwordx4 v16, s[28:31], s3 offen lds
    s_waitcnt vmcnt(8)
    s_add_u32 m0, s82, 13312
    s_add_u32 s3, s85, 237568
    buffer_load_dwordx4 v16, s[28:31], s3 offen lds
    s_waitcnt vmcnt(8)
    s_add_u32 m0, s82, 14336
    s_add_u32 s3, s85, 425984
    buffer_load_dwordx4 v16, s[28:31], s3 offen lds
    s_waitcnt vmcnt(8)
    s_add_u32 m0, s82, 15360
    s_add_u32 s3, s85, 434176
    buffer_load_dwordx4 v16, s[28:31], s3 offen lds
    s_waitcnt vmcnt(8)
    s_waitcnt vmcnt(0)
    ds_write_b32 v6, v6 offset:176
    s_mov_b32 s53, 0
    s_nop 0
L_lw_44:
    ds_read_b32 v13, v8 offset:144
    s_add_u32 s53, s53, 1
    s_cmp_gt_u32 s53, 1048576
    s_cbranch_scc1 L_lg_45
    s_sleep 1
    s_waitcnt lgkmcnt(0)
    v_cmp_eq_u32 vcc, 0, v13
    s_nop 0
    s_cbranch_vccnz L_lw_44
    s_nop 2
L_lg_45:
    ds_write_b128 v24, v[28:31] offset:0
    ds_write_b128 v24, v[32:35] offset:1024
    ds_write_b128 v24, v[36:39] offset:2048
    ds_write_b128 v24, v[40:43] offset:3072
    ds_write_b128 v24, v[44:47] offset:4096
    ds_write_b128 v24, v[48:51] offset:5120
    ds_write_b128 v24, v[52:55] offset:6144
    ds_write_b128 v24, v[56:59] offset:7168
    ds_write_b128 v24, v[60:63] offset:8192
    ds_write_b128 v24, v[64:67] offset:9216
    ds_write_b128 v24, v[68:71] offset:10240
    ds_write_b128 v24, v[72:75] offset:11264
    ds_write_b128 v24, v[76:79] offset:12288
    ds_write_b128 v24, v[80:83] offset:13312
    ds_write_b128 v24, v[84:87] offset:14336
    ds_write_b128 v24, v[88:91] offset:15360
    ds_write_b32 v6, v6 offset:192
    s_mov_b32 s53, 0
    s_nop 0
L_lw_46:
    ds_read_b32 v13, v7 offset:224
    s_add_u32 s53, s53, 1
    s_cmp_gt_u32 s53, 1048576
    s_cbranch_scc1 L_lg_47
    s_sleep 1
    s_waitcnt lgkmcnt(0)
    v_cmp_eq_u32 vcc, 0, v13
    s_nop 0
    s_cbranch_vccnz L_lw_46
    s_nop 2
L_lg_47:
    ds_write_b128 v22, v[92:95] offset:0
    ds_write_b128 v22, v[96:99] offset:1024
    ds_write_b128 v22, v[100:103] offset:2048
    ds_write_b128 v22, v[104:107] offset:3072
    ds_write_b128 v22, v[108:111] offset:4096
    ds_write_b128 v22, v[112:115] offset:5120
    ds_write_b32 v6, v6 offset:208
    s_endpgm
L_job:
    s_and_b32 s90, s44, 1
    s_lshl_b32 s4, s2, 1
    s_add_u32 s98, s4, s90
    s_cmp_lt_u32 s98, 480
    s_cselect_b32 s91, 0, 0x80000000
    s_mul_i32 s7, s98, 4370
    s_lshr_b32 s7, s7, 16
    s_mul_i32 s6, s7, 15
    s_sub_u32 s6, s98, s6
    s_and_b32 s7, s7, 31
    s_lshl_b32 s92, s6, 5
    s_add_u32 s92, s92, s7
    s_mul_i32 s94, s6, 196608
    s_lshl_b32 s4, s7, 10
    s_add_u32 s94, s94, s4
    s_add_u32 s94, s94, 13631488
    s_mul_i32 s6, s6, 192
    s_mul_i32 s7, s7, 44032
    s_add_u32 s6, s6, s7
    s_or_b32 s6, s6, s91
    v_add_u32 v11, 0, v1
    v_mul_u32_u24 v12, 5462, v11
    v_lshrrev_b32 v12, 16, v12
    v_mul_u32_u24 v12, 2560, v12
    v_lshl_add_u32 v12, v11, 4, v12
    v_add_u32 v76, s6, v12
    v_add_u32 v11, 64, v1
    v_mul_u32_u24 v12, 5462, v11
    v_lshrrev_b32 v12, 16, v12
    v_mul_u32_u24 v12, 2560, v12
    v_lshl_add_u32 v12, v11, 4, v12
    v_add_u32 v77, s6, v12
    v_add_u32 v11, 128, v1
    v_mul_u32_u24 v12, 5462, v11
    v_lshrrev_b32 v12, 16, v12
    v_mul_u32_u24 v12, 2560, v12
    v_lshl_add_u32 v12, v11, 4, v12
    v_add_u32 v78, s6, v12
    s_mul_i32 s95, s90, 6208
    s_add_u32 s95, s95, 139264
    s_lshl_b32 s6, s5, 1
    s_add_u32 s99, s6, s90
    v_mov_b32 v12, 0x80000000
    s_mul_i32 s6, s99, 24
    v_add_u32 v11, s6, v1
    v_lshlrev_b32 v11, 10, v11
    v_cmp_gt_u32 vcc, 24, v1
    s_nop 1
    v_cndmask_b32 v87, v12, v11, vcc
    s_mul_i32 s6, s98, 22
    v_add_u32 v11, s6, v1
    v_lshlrev_b32 v11, 7, v11
    v_cmp_gt_u32 vcc, 22, v1
    s_nop 1
    v_cndmask_b32 v79, v12, v11, vcc
    s_lshl_b32 s6, s98, 3
    v_add_u32 v11, s6, v1
    v_lshlrev_b32 v11, 7, v11
    v_cmp_gt_u32 vcc, 8, v1
    s_nop 1
    v_cndmask_b32 v86, v12, v11, vcc
    s_lshl_b32 s6, s99, 3
    s_sub_u32 s6, s6, 8
    v_add_u32 v11, s6, v1
    v_lshlrev_b32 v11, 10, v11
    v_add_u32 v11, 384, v11
    s_mov_b32 s6, 0xff00
    s_mov_b32 s7, 0
    v_cndmask_b32 v86, v86, v11, s[6:7]
    s_waitcnt lgkmcnt(0)
    s_mov_b32 s12, s50
    s_and_b32 s13, s51, 0xffff
    s_mov_b32 s14, 1572864
    s_mov_b32 s15, 0x20000
    s_mov_b32 s20, s56
    s_and_b32 s21, s57, 0xffff
    s_mov_b32 s22, 1409024
    s_mov_b32 s23, 0x20000
    s_mov_b32 s24, s58
    s_and_b32 s25, s59, 0xffff
    s_mov_b32 s26, 1409024
    s_mov_b32 s27, 0x20000
    s_mov_b32 s16, s52
    s_and_b32 s17, s53, 0xffff
    s_mov_b32 s18, 524288
    s_mov_b32 s19, 0x20000
    s_mov_b32 s28, s60
    s_and_b32 s29, s61, 0xffff
    s_mov_b32 s30, 1409024
    s_mov_b32 s31, 0x20000
    buffer_load_dword v87, v87, s[12:15], 0 offen offset:384
    buffer_load_dword v84, v86, s[16:19], 0 offen
    s_lshl_b32 s4, s44, 2
    s_add_u32 s4, s4, 162816
    v_mov_b32 v7, s4
    v_mov_b32 v11, 0x40000
    v_cmp_eq_u32 vcc, 0, v1
    s_nop 1
    v_cndmask_b32 v6, v11, v7, vcc
    v_and_b32 v11, 3, v1
    v_lshlrev_b32 v11, 2, v11
    v_add_u32 v8, 162816, v11
    s_barrier
    ds_write_b32 v6, v6 offset:352
    ds_write_b32 v6, v6 offset:368
    ds_write_b32 v6, v6 offset:384
    ds_write_b32 v6, v6 offset:400
    ds_write_b32 v6, v6 offset:416
    ds_write_b32 v6, v6 offset:432
    ds_write_b32 v6, v6 offset:448
    ds_write_b32 v6, v6 offset:464
    ds_write_b32 v6, v6 offset:480
    ds_write_b32 v6, v6 offset:336
    ds_write_b32 v6, v6 offset:656
    ds_write_b32 v6, v6 offset:672
    v_mov_b32 v10, 0
    v_lshlrev_b32 v9, 3, v1
    s_mov_b32 s16, s52
    s_and_b32 s17, s53, 0xffff
    s_mov_b32 s18, 524288
    s_mov_b32 s19, 0x20000
    s_mov_b32 s28, s60
    s_and_b32 s29, s61, 0xffff
    s_mov_b32 s30, 1409024
    s_mov_b32 s31, 0x20000
    s_mov_b32 s40, s66
    s_and_b32 s41, s67, 0xffff
    s_mov_b32 s42, 16777216
    s_mov_b32 s43, 0x20000
    s_and_b32 s4, s2, 7
    s_lshl_b32 s4, s4, 1
    s_lshr_b32 s6, s2, 7
    s_add_u32 s47, s4, s6
    s_lshr_b32 s4, s2, 3
    s_and_b32 s68, s4, 15
    s_mov_b32 s6, 0x7654e210
    s_mov_b32 s7, 0xb3dcfa98
    s_lshl_b32 s4, s68, 2
    s_lshr_b64 s[6:7], s[6:7], s4
    s_and_b32 s68, s6, 15
    v_bfe_u32 v11, v1, 4, 1
    v_lshlrev_b32 v11, 2, v11
    v_and_b32 v12, 7, v1
    v_xor_b32 v11, v11, v12
    v_lshlrev_b32 v11, 4, v11
    v_lshrrev_b32 v12, 3, v1
    v_lshl_add_u32 v11, v12, 10, v11
    s_lshl_b32 s4, s46, 7
    v_add_u32 v16, s4, v11
    s_lshl_b32 s6, s44, 14
    s_add_u32 s82, s6, 65536
    s_lshl_b32 s83, s44, 17
    s_lshl_b32 s88, s44, 12
    s_mul_i32 s4, s68, 196608
    s_add_u32 s4, s4, s88
    s_add_u32 s84, s4, 13631488
    s_cmp_ge_u32 s68, 14
    s_cselect_b32 s4, 0x80000000, 0
    v_or_b32 v18, s4, v2
    s_cmp_eq_u32 s68, 15
    s_cselect_b32 s4, 0x80000000, 0
    s_cselect_b32 s6, 0, s68
    v_or_b32 v17, s4, v2
    s_lshl_b32 s6, s6, 3
    s_add_u32 s6, s6, s44
    s_lshl_b32 s7, s6, 9
    s_add_u32 s7, s7, 11403264
    v_and_b32 v11, 3, v1
    v_bfe_u32 v12, v1, 2, 1
    v_lshl_add_u32 v11, v12, 4, v11
    v_lshl_add_u32 v20, v11, 7, s7
    s_lshl_b32 s6, s6, 12
    s_add_u32 s89, s6, 10764288
    v_mul_u32_u24 v21, 12, v1
    s_mul_i32 s4, s44, 6144
    s_add_u32 s4, s4, 131072
    v_add_u32 v22, s4, v2
    s_mov_b32 s87, s4
    s_mul_i32 s4, s44, 16384
    s_add_u32 s4, s4, 65536
    v_add_u32 v23, s4, v2
    s_mul_i32 s4, s44, 16384
    s_add_u32 s4, s4, 0
    v_add_u32 v24, s4, v2
    s_lshr_b32 s4, s44, 1
    s_mul_i32 s4, s4, 6
    s_and_b32 s7, s44, 1
    s_add_u32 s4, s4, s7
    s_lshl_b32 s85, s4, 14
    s_lshl_b32 s86, s7, 14
    s_mov_b32 s8, s48
    s_and_b32 s9, s49, 0xffff
    s_mov_b32 s10, 2097152
    s_mov_b32 s11, 0x20000
    s_mov_b32 s36, s64
    s_and_b32 s37, s65, 0xffff
    s_mov_b32 s38, 256
    s_mov_b32 s39, 0x20000
    s_lshl_b32 s93, s92, 10
    s_add_u32 s93, s93, 10764288
    s_lshl_b32 s92, s92, 7
    s_add_u32 s92, s92, 11403264
    v_bfe_u32 v12, v1, 4, 1
    v_mul_u32_u24 v11, 3104, v12
    v_lshrrev_b32 v12, 5, v1
    v_mul_u32_u24 v12, 1536, v12
    v_add_u32 v11, v11, v12
    v_bfe_u32 v12, v1, 2, 2
    v_mul_u32_u24 v12, 192, v12
    v_add_u32 v11, v11, v12
    v_and_b32 v12, 1, v1
    v_lshl_add_u32 v11, v12, 4, v11
    v_bfe_u32 v12, v1, 1, 1
    v_lshl_add_u32 v11, v12, 3, v11
    v_add_u32 v80, s95, v11
    v_or_b32 v81, s91, v2
    v_or_b32 v83, s91, v9
    v_or_b32 v82, s91, v21
    v_mov_b32 v252, 0x3f803f80
    v_mov_b32 v253, 0x3f803f80
    v_mov_b32 v254, 0x3f803f80
    v_mov_b32 v255, 0x3f803f80
    s_lshr_b32 s4, s2, 6
    s_and_b32 s4, s4, 3
    s_lshl_b32 s4, s4, 4
    v_add_u32 v15, s4, v8
    s_lshl_b32 s96, s45, 6
    s_lshl_b32 s4, s46, 3
    s_add_u32 s96, s96, s4
    s_lshl_b32 s4, s90, 2
    s_add_u32 s96, s96, s4
    s_mov_b32 s53, 0
    s_nop 0
L_lw_17:
    ds_read_b32 v13, v8 offset:352
    s_add_u32 s53, s53, 1
    s_cmp_gt_u32 s53, 1048576
    s_cbranch_scc1 L_lg_18
    s_sleep 2
    s_waitcnt lgkmcnt(0)
    v_cmp_eq_u32 vcc, 0, v13
    s_nop 0
    s_cbranch_vccnz L_lw_17
    s_nop 2
L_lg_18:
    s_lshl_b32 s4, s96, 10
    buffer_load_dwordx4 v[92:95], v2, s[8:11], s4 offen offset:0
    buffer_load_dwordx4 v[96:99], v2, s[8:11], s4 offen offset:1024
    buffer_load_dwordx4 v[100:103], v2, s[8:11], s4 offen offset:2048
    buffer_load_dwordx4 v[104:107], v2, s[8:11], s4 offen offset:3072
    buffer_load_dwordx2 v[4:5], v10, s[36:39], 0 offen sc1
    s_waitcnt vmcnt(4)
    v_lshlrev_b32 v124, 16, v92
    v_and_b32 v125, 0xffff0000, v92
    v_lshlrev_b32 v126, 16, v93
    v_and_b32 v127, 0xffff0000, v93
    v_lshlrev_b32 v128, 16, v94
    v_and_b32 v129, 0xffff0000, v94
    v_lshlrev_b32 v130, 16, v95
    v_and_b32 v131, 0xffff0000, v95
    v_add_f32 v108, v124, v125
    v_mul_f32 v112, v124, v124
    v_fmac_f32 v112, v125, v125
    v_add_f32 v108, v108, v126
    v_fmac_f32 v112, v126, v126
    v_add_f32 v108, v108, v127
    v_fmac_f32 v112, v127, v127
    v_add_f32 v108, v108, v128
    v_fmac_f32 v112, v128, v128
    v_add_f32 v108, v108, v129
    v_fmac_f32 v112, v129, v129
    v_add_f32 v108, v108, v130
    v_fmac_f32 v112, v130, v130
    v_add_f32 v108, v108, v131
    v_fmac_f32 v112, v131, v131
    s_waitcnt vmcnt(3)
    v_lshlrev_b32 v124, 16, v96
    v_and_b32 v125, 0xffff0000, v96
    v_lshlrev_b32 v126, 16, v97
    v_and_b32 v127, 0xffff0000, v97
    v_lshlrev_b32 v128, 16, v98
    v_and_b32 v129, 0xffff0000, v98
    v_lshlrev_b32 v130, 16, v99
    v_and_b32 v131, 0xffff0000, v99
    v_add_f32 v109, v124, v125
    v_mul_f32 v113, v124, v124
    v_fmac_f32 v113, v125, v125
    v_add_f32 v109, v109, v126
    v_fmac_f32 v113, v126, v126
    v_add_f32 v109, v109, v127
    v_fmac_f32 v113, v127, v127
    v_add_f32 v109, v109, v128
    v_fmac_f32 v113, v128, v128
    v_add_f32 v109, v109, v129
    v_fmac_f32 v113, v129, v129
    v_add_f32 v109, v109, v130
    v_fmac_f32 v113, v130, v130
    v_add_f32 v109, v109, v131
    v_fmac_f32 v113, v131, v131
    s_waitcnt vmcnt(2)
    v_lshlrev_b32 v124, 16, v100
    v_and_b32 v125, 0xffff0000, v100
    v_lshlrev_b32 v126, 16, v101
    v_and_b32 v127, 0xffff0000, v101
    v_lshlrev_b32 v128, 16, v102
    v_and_b32 v129, 0xffff0000, v102
    v_lshlrev_b32 v130, 16, v103
    v_and_b32 v131, 0xffff0000, v103
    v_add_f32 v110, v124, v125
    v_mul_f32 v114, v124, v124
    v_fmac_f32 v114, v125, v125
    v_add_f32 v110, v110, v126
    v_fmac_f32 v114, v126, v126
    v_add_f32 v110, v110, v127
    v_fmac_f32 v114, v127, v127
    v_add_f32 v110, v110, v128
    v_fmac_f32 v114, v128, v128
    v_add_f32 v110, v110, v129
    v_fmac_f32 v114, v129, v129
    v_add_f32 v110, v110, v130
    v_fmac_f32 v114, v130, v130
    v_add_f32 v110, v110, v131
    v_fmac_f32 v114, v131, v131
    s_waitcnt vmcnt(1)
    v_lshlrev_b32 v124, 16, v104
    v_and_b32 v125, 0xffff0000, v104
    v_lshlrev_b32 v126, 16, v105
    v_and_b32 v127, 0xffff0000, v105
    v_lshlrev_b32 v128, 16, v106
    v_and_b32 v129, 0xffff0000, v106
    v_lshlrev_b32 v130, 16, v107
    v_and_b32 v131, 0xffff0000, v107
    v_add_f32 v111, v124, v125
    v_mul_f32 v115, v124, v124
    v_fmac_f32 v115, v125, v125
    v_add_f32 v111, v111, v126
    v_fmac_f32 v115, v126, v126
    v_add_f32 v111, v111, v127
    v_fmac_f32 v115, v127, v127
    v_add_f32 v111, v111, v128
    v_fmac_f32 v115, v128, v128
    v_add_f32 v111, v111, v129
    v_fmac_f32 v115, v129, v129
    v_add_f32 v111, v111, v130
    v_fmac_f32 v115, v130, v130
    v_add_f32 v111, v111, v131
    v_fmac_f32 v115, v131, v131
    v_add_f32_dpp v108, v108, v108 row_ror:8 row_mask:0xf bank_mask:0xf
    v_add_f32_dpp v109, v109, v109 row_ror:8 row_mask:0xf bank_mask:0xf
    v_add_f32_dpp v110, v110, v110 row_ror:8 row_mask:0xf bank_mask:0xf
    v_add_f32_dpp v111, v111, v111 row_ror:8 row_mask:0xf bank_mask:0xf
    v_add_f32_dpp v112, v112, v112 row_ror:8 row_mask:0xf bank_mask:0xf
    v_add_f32_dpp v113, v113, v113 row_ror:8 row_mask:0xf bank_mask:0xf
    v_add_f32_dpp v114, v114, v114 row_ror:8 row_mask:0xf bank_mask:0xf
    v_add_f32_dpp v115, v115, v115 row_ror:8 row_mask:0xf bank_mask:0xf
    v_add_f32_dpp v108, v108, v108 row_ror:4 row_mask:0xf bank_mask:0xf
    v_add_f32_dpp v109, v109, v109 row_ror:4 row_mask:0xf bank_mask:0xf
    v_add_f32_dpp v110, v110, v110 row_ror:4 row_mask:0xf bank_mask:0xf
    v_add_f32_dpp v111, v111, v111 row_ror:4 row_mask:0xf bank_mask:0xf
    v_add_f32_dpp v112, v112, v112 row_ror:4 row_mask:0xf bank_mask:0xf
    v_add_f32_dpp v113, v113, v113 row_ror:4 row_mask:0xf bank_mask:0xf
    v_add_f32_dpp v114, v114, v114 row_ror:4 row_mask:0xf bank_mask:0xf
    v_add_f32_dpp v115, v115, v115 row_ror:4 row_mask:0xf bank_mask:0xf
    v_add_f32_dpp v108, v108, v108 row_ror:2 row_mask:0xf bank_mask:0xf
    v_add_f32_dpp v109, v109, v109 row_ror:2 row_mask:0xf bank_mask:0xf
    v_add_f32_dpp v110, v110, v110 row_ror:2 row_mask:0xf bank_mask:0xf
    v_add_f32_dpp v111, v111, v111 row_ror:2 row_mask:0xf bank_mask:0xf
    v_add_f32_dpp v112, v112, v112 row_ror:2 row_mask:0xf bank_mask:0xf
    v_add_f32_dpp v113, v113, v113 row_ror:2 row_mask:0xf bank_mask:0xf
    v_add_f32_dpp v114, v114, v114 row_ror:2 row_mask:0xf bank_mask:0xf
    v_add_f32_dpp v115, v115, v115 row_ror:2 row_mask:0xf bank_mask:0xf
    v_add_f32_dpp v108, v108, v108 row_ror:1 row_mask:0xf bank_mask:0xf
    v_add_f32_dpp v109, v109, v109 row_ror:1 row_mask:0xf bank_mask:0xf
    v_add_f32_dpp v110, v110, v110 row_ror:1 row_mask:0xf bank_mask:0xf
    v_add_f32_dpp v111, v111, v111 row_ror:1 row_mask:0xf bank_mask:0xf
    v_add_f32_dpp v112, v112, v112 row_ror:1 row_mask:0xf bank_mask:0xf
    v_add_f32_dpp v113, v113, v113 row_ror:1 row_mask:0xf bank_mask:0xf
    v_add_f32_dpp v114, v114, v114 row_ror:1 row_mask:0xf bank_mask:0xf
    v_add_f32_dpp v115, v115, v115 row_ror:1 row_mask:0xf bank_mask:0xf
    v_mov_b32 v124, v108
    v_mov_b32 v125, v109
    v_mov_b32 v126, v110
    v_mov_b32 v127, v111
    v_mov_b32 v128, v112
    v_mov_b32 v129, v113
    v_mov_b32 v130, v114
    v_mov_b32 v131, v115
    v_permlane16_swap_b32 v108, v124
    v_permlane16_swap_b32 v109, v125
    v_permlane16_swap_b32 v110, v126
    v_permlane16_swap_b32 v111, v127
    v_permlane16_swap_b32 v112, v128
    v_permlane16_swap_b32 v113, v129
    v_permlane16_swap_b32 v114, v130
    v_permlane16_swap_b32 v115, v131
    v_add_f32 v108, v108, v124
    v_add_f32 v109, v109, v125
    v_add_f32 v110, v110, v126
    v_add_f32 v111, v111, v127
    v_add_f32 v112, v112, v128
    v_add_f32 v113, v113, v129
    v_add_f32 v114, v114, v130
    v_add_f32 v115, v115, v131
    v_mov_b32 v124, v108
    v_mov_b32 v125, v109
    v_mov_b32 v126, v110
    v_mov_b32 v127, v111
    v_mov_b32 v128, v112
    v_mov_b32 v129, v113
    v_mov_b32 v130, v114
    v_mov_b32 v131, v115
    v_permlane32_swap_b32 v108, v124
    v_permlane32_swap_b32 v109, v125
    v_permlane32_swap_b32 v110, v126
    v_permlane32_swap_b32 v111, v127
    v_permlane32_swap_b32 v112, v128
    v_permlane32_swap_b32 v113, v129
    v_permlane32_swap_b32 v114, v130
    v_permlane32_swap_b32 v115, v131
    v_add_f32 v108, v108, v124
    v_add_f32 v109, v109, v125
    v_add_f32 v110, v110, v126
    v_add_f32 v111, v111, v127
    v_add_f32 v112, v112, v128
    v_add_f32 v113, v113, v129
    v_add_f32 v114, v114, v130
    v_add_f32 v115, v115, v131
    v_cmp_eq_u32 vcc, 1, v1
    s_nop 1
    v_cndmask_b32 v108, v108, v109, vcc
    v_cndmask_b32 v112, v112, v113, vcc
    v_cmp_eq_u32 vcc, 2, v1
    s_nop 1
    v_cndmask_b32 v108, v108, v110, vcc
    v_cndmask_b32 v112, v112, v114, vcc
    v_cmp_eq_u32 vcc, 3, v1
    s_nop 1
    v_cndmask_b32 v108, v108, v111, vcc
    v_cndmask_b32 v112, v112, v115, vcc
    v_mul_f32 v132, 0x3b000000, v108
    v_mul_f32 v112, 0x3b000000, v112
    v_fma_f32 v112, -v132, v132, v112
    v_max_f32 v112, 0, v112
    v_cvt_pk_bf16_f32 v132, v132, v132
    v_and_b32 v132, 0xffff0000, v132
    v_cvt_pk_bf16_f32 v112, v112, v112
    v_and_b32 v112, 0xffff0000, v112
    v_add_f32 v112, 0x3727c5ac, v112
    v_cvt_pk_bf16_f32 v112, v112, v112
    v_and_b32 v112, 0xffff0000, v112
    v_sqrt_f32 v112, v112
    s_nop 0
    v_cvt_pk_bf16_f32 v112, v112, v112
    v_and_b32 v112, 0xffff0000, v112
    v_rcp_f32 v134, v112
    s_mov_b32 s52, 0
    s_nop 0
L_jn:
    s_waitcnt vmcnt(0)
    v_readfirstlane_b32 s70, v4
    v_readfirstlane_b32 s71, v5
    s_cmp_lg_u32 s70, 0
    s_nop 3
    s_cbranch_scc1 L_jn2
    buffer_load_dwordx2 v[4:5], v10, s[36:39], 0 offen sc1
    s_add_u32 s52, s52, 1
    s_waitcnt vmcnt(0)
    s_cmp_lt_u32 s52, 65536
    s_nop 0
    s_cbranch_scc1 L_jn
L_jn2:
    v_mov_b32 v133, s70
    v_mov_b32 v135, s70
    s_lshl_b32 s4, s96, 4
    s_add_u32 s4, s4, 11288576
    s_mov_b64 exec, 15
    buffer_store_dwordx4 v[132:135], v2, s[40:43], s4 offen sc1
    s_mov_b64 exec, -1
    s_lshl_b32 s4, s90, 6
    v_add_u32 v11, s4, v1
    v_min_u32 v11, 79, v11
    s_lshl_b32 s4, s45, 6
    s_sub_u32 s4, s4, 16
    v_add_u32 v12, s4, v11
    v_max_i32 v12, 0, v12
    v_lshlrev_b32 v12, 4, v12
    v_add_u32 v12, 11288576, v12
    v_lshlrev_b32 v11, 2, v11
    v_add_u32 v11, 155648, v11
    s_mov_b32 s53, 0
    s_nop 0
L_lw_19:
    ds_read_b32 v13, v8 offset:432
    s_add_u32 s53, s53, 1
    s_cmp_gt_u32 s53, 1048576
    s_cbranch_scc1 L_lg_20
    s_sleep 2
    s_waitcnt lgkmcnt(0)
    v_cmp_eq_u32 vcc, 0, v13
    s_nop 0
    s_cbranch_vccnz L_lw_19
    s_nop 2
L_lg_20:
    s_mov_b32 s52, 0
    s_nop 0
L_jg:
    buffer_load_dwordx4 v[132:135], v12, s[40:43], 0 offen sc1
    s_add_u32 s52, s52, 1
    s_cmp_gt_u32 s52, 65536
    s_cbranch_scc1 L_jg2
    s_waitcnt vmcnt(0)
    v_cmp_ne_u32 vcc, s70, v133
    v_cmp_ne_u32 s[6:7], s70, v135
    s_nop 0
    s_or_b64 vcc, vcc, s[6:7]
    s_cbranch_vccz L_jg2
    s_sleep 4
    s_nop 0
    s_branch L_jg
L_jg2:
    ds_write_b32 v11, v132
    ds_write_b32 v11, v134 offset:512
    v_mov_b32 v11, 163824
    ds_write_b64 v11, v[4:5]
    ds_write_b32 v6, v6 offset:256
    s_mov_b32 s53, 0
    s_nop 0
L_lw_21:
    ds_read_b32 v13, v8 offset:336
    s_add_u32 s53, s53, 1
    s_cmp_gt_u32 s53, 1048576
    s_cbranch_scc1 L_lg_22
    s_sleep 1
    s_waitcnt lgkmcnt(0)
    v_cmp_eq_u32 vcc, 0, v13
    s_nop 0
    s_cbranch_vccnz L_lw_21
    s_nop 2
L_lg_22:
    s_add_u32 m0, s95, 0
    s_nop 0
    buffer_load_dwordx4 v76, s[20:23], 0 offen lds
    s_add_u32 m0, s95, 1024
    s_nop 0
    buffer_load_dwordx4 v77, s[20:23], 0 offen lds
    s_add_u32 m0, s95, 2048
    s_nop 0
    buffer_load_dwordx4 v78, s[20:23], 0 offen lds
    s_add_u32 m0, s95, 3104
    s_nop 0
    buffer_load_dwordx4 v76, s[24:27], 0 offen lds
    s_add_u32 m0, s95, 4128
    s_nop 0
    buffer_load_dwordx4 v77, s[24:27], 0 offen lds
    s_add_u32 m0, s95, 5152
    s_nop 0
    buffer_load_dwordx4 v78, s[24:27], 0 offen lds
    buffer_load_dword v85, v79, s[28:31], 0 offen
    s_waitcnt vmcnt(0)
    ds_read_b64_tr_b16 v[52:53], v80 offset:0
    ds_read_b64_tr_b16 v[54:55], v80 offset:768
    ds_read_b64_tr_b16 v[56:57], v80 offset:32
    ds_read_b64_tr_b16 v[58:59], v80 offset:800
    ds_read_b64_tr_b16 v[60:61], v80 offset:64
    ds_read_b64_tr_b16 v[62:63], v80 offset:832
    ds_read_b64_tr_b16 v[64:65], v80 offset:96
    ds_read_b64_tr_b16 v[66:67], v80 offset:864
    ds_read_b64_tr_b16 v[68:69], v80 offset:128
    ds_read_b64_tr_b16 v[70:71], v80 offset:896
    ds_read_b64_tr_b16 v[72:73], v80 offset:160
    ds_read_b64_tr_b16 v[74:75], v80 offset:928
    ds_write_b32 v6, v6 offset:320
    s_add_u32 s4, s94, 0
    s_waitcnt lgkmcnt(11)
    buffer_store_dwordx4 v[52:55], v81, s[40:43], s4 offen sc1
    s_add_u32 s4, s94, 32768
    s_waitcnt lgkmcnt(9)
    buffer_store_dwordx4 v[56:59], v81, s[40:43], s4 offen sc1
    s_add_u32 s4, s94, 65536
    s_waitcnt lgkmcnt(7)
    buffer_store_dwordx4 v[60:63], v81, s[40:43], s4 offen sc1
    s_add_u32 s4, s94, 98304
    s_waitcnt lgkmcnt(5)
    buffer_store_dwordx4 v[64:67], v81, s[40:43], s4 offen sc1
    s_add_u32 s4, s94, 131072
    s_waitcnt lgkmcnt(3)
    buffer_store_dwordx4 v[68:71], v81, s[40:43], s4 offen sc1
    s_add_u32 s4, s94, 163840
    s_waitcnt lgkmcnt(1)
    buffer_store_dwordx4 v[72:75], v81, s[40:43], s4 offen sc1
    s_mov_b32 s6, 0
    s_mov_b32 s7, -1
    v_mfma_f32_32x32x16_bf16 v[236:251], v[252:255], v[52:55], 0
    v_mfma_f32_32x32x16_bf16 v[28:43], v[252:255], v[56:59], 0
    v_mfma_f32_32x32x16_bf16 v[92:107], v[252:255], v[60:63], 0
    v_mfma_f32_32x32x16_bf16 v[108:123], v[252:255], v[64:67], 0
    v_mfma_f32_32x32x16_bf16 v[140:155], v[252:255], v[68:71], 0
    v_mfma_f32_32x32x16_bf16 v[156:171], v[252:255], v[72:75], 0
    s_nop 7
    v_cndmask_b32 v88, v236, v28, s[6:7]
    s_nop 0
    v_cndmask_b32 v89, v92, v108, s[6:7]
    s_nop 0
    v_cndmask_b32 v90, v140, v156, s[6:7]
    buffer_store_dwordx3 v[88:90], v82, s[40:43], s93 offen sc1
    s_waitcnt vmcnt(0)
    s_mov_b64 exec, 0xffff
    buffer_store_dwordx2 v[4:5], v83, s[40:43], s92 offen sc1
    s_mov_b64 exec, -1
    s_mov_b32 s53, 0
    s_nop 0
L_lw_23:
    ds_read_b32 v13, v8 offset:240
    s_add_u32 s53, s53, 1
    s_cmp_gt_u32 s53, 1048576
    s_cbranch_scc1 L_lg_24
    s_sleep 2
    s_waitcnt lgkmcnt(0)
    v_cmp_eq_u32 vcc, 0, v13
    s_nop 0
    s_cbranch_vccnz L_lw_23
    s_nop 2
L_lg_24:
    s_waitcnt vmcnt(0)
    s_branch L_sym
L_compute:
    s_setprio 1
    s_getpc_b64 s[6:7]
L_pc:
    s_sub_u32 s6, s6, L_pc-sequential_preLN__sliding_local_dilated__glu_gated_geglu__prompt_kernel
    s_subb_u32 s7, s7, 0
    v_lshrrev_b32 v24, 4, v0
    v_lshl_add_u32 v24, s5, 4, v24
    v_lshlrev_b32 v24, 7, v24
    v_min_u32 v24, L_codeend-sequential_preLN__sliding_local_dilated__glu_gated_geglu__prompt_kernel-4, v24
    global_load_dword v20, v24, s[6:7]
    v_lshlrev_b32 v9, 3, v1
    v_lshlrev_b32 v11, 2, v1
    v_mov_b32 v10, 0
    v_mov_b32 v28, 0x3f803f80
    v_mov_b32 v12, 0
    v_mov_b32 v29, 0x3f803f80
    v_mov_b32 v13, 0
    v_mov_b32 v30, 0x3f803f80
    v_mov_b32 v14, 0
    v_mov_b32 v31, 0x3f803f80
    v_mov_b32 v15, 0
    v_bfe_u32 v24, v1, 3, 2
    v_mul_u32_u24 v24, 34816, v24
    v_and_b32 v25, 7, v1
    v_lshl_add_u32 v24, v25, 4, v24
    ds_write_b128 v24, v[28:31]
    v_add_u32 v24, 162816, v2
    ds_write_b128 v24, v[12:15]
    v_mov_b32 v26, 0
    s_mov_b32 s3, 2101248
    v_writelane_b32 v26, s3, 1
    s_mov_b32 s3, 4202496
    v_writelane_b32 v26, s3, 2
    s_mov_b32 s3, 6463488
    v_writelane_b32 v26, s3, 3
    s_mov_b32 s3, 8527872
    v_writelane_b32 v26, s3, 4
    s_mov_b32 s3, 10498048
    v_writelane_b32 v26, s3, 5
    s_mov_b32 s3, 13565952
    v_writelane_b32 v26, s3, 6
    s_mov_b32 s3, 16711680
    v_writelane_b32 v26, s3, 7
    s_or_b32 s3, s2, s44
    s_waitcnt lgkmcnt(0)
    s_mov_b32 s36, s64
    s_and_b32 s37, s65, 0xffff
    s_mov_b32 s38, 256
    s_mov_b32 s39, 0x20000
    s_cmp_eq_u32 s3, 0
    s_nop 0
    s_cbranch_scc1 L_pubnonce
L_pubdone:
    s_mov_b32 s8, s48
    s_and_b32 s9, s49, 0xffff
    s_mov_b32 s10, 2097152
    s_mov_b32 s11, 0x20000
    s_mov_b32 s32, s62
    s_and_b32 s33, s63, 0xffff
    s_mov_b32 s34, 2097152
    s_mov_b32 s35, 0x20000
    s_mov_b32 s40, s66
    s_and_b32 s41, s67, 0xffff
    s_mov_b32 s42, 16777216
    s_mov_b32 s43, 0x20000
    s_cmp_eq_u32 s44, 1
    s_cselect_b64 s[6:7], s[56:57], s[52:53]
    s_cmp_eq_u32 s44, 2
    s_cselect_b64 s[6:7], s[58:59], s[6:7]
    s_cmp_eq_u32 s44, 3
    s_cselect_b64 s[6:7], s[60:61], s[6:7]
    s_mov_b32 s20, s6
    s_and_b32 s21, s7, 0xffff
    s_mov_b32 s22, 4096
    s_mov_b32 s23, 0x20000
    buffer_load_dword v23, v10, s[20:23], 0 offen
    buffer_load_dword v22, v26, s[40:43], 0 offen
    s_barrier
    s_and_b32 s4, s2, 7
    s_lshl_b32 s4, s4, 1
    s_lshr_b32 s6, s2, 7
    s_add_u32 s47, s4, s6
    s_lshr_b32 s4, s2, 3
    s_and_b32 s68, s4, 15
    s_mov_b32 s6, 0x7654e210
    s_mov_b32 s7, 0xb3dcfa98
    s_lshl_b32 s4, s68, 2
    s_lshr_b64 s[6:7], s[6:7], s4
    s_and_b32 s68, s6, 15
    s_lshl_b32 s4, s44, 2
    s_add_u32 s4, s4, 162816
    v_mov_b32 v7, s4
    v_mov_b32 v24, 0x40000
    v_cmp_eq_u32 vcc, 0, v1
    s_nop 1
    v_cndmask_b32 v6, v24, v7, vcc
    v_and_b32 v24, 3, v1
    v_lshlrev_b32 v24, 2, v24
    v_add_u32 v8, 162816, v24
    s_lshl_b32 s4, s46, 2
    s_add_u32 s4, s4, s44
    s_lshl_b32 s6, s45, 6
    s_add_u32 s6, s6, s4
    s_lshl_b32 s6, s6, 10
    s_add_u32 s74, s6, 4096
    s_add_u32 s75, s74, 32768
    s_lshl_b32 s6, s45, 5
    s_add_u32 s6, s6, s4
    s_lshl_b32 s6, s6, 3
    s_add_u32 s76, s6, 11337728
    s_lshr_b32 s4, s44, 1
    s_mul_i32 s4, s4, 6
    s_and_b32 s7, s44, 1
    s_add_u32 s5, s4, s7
    s_lshr_b32 s4, s44, 1
    s_xor_b32 s4, s4, 0
    s_lshl_b32 s6, s45, 1
    s_add_u32 s4, s4, s6
    s_lshl_b32 s6, s4, 5
    s_lshl_b32 s7, s44, 3
    s_add_u32 s6, s6, s7
    s_lshl_b32 s6, s6, 10
    s_add_u32 s77, s6, 4096
    s_add_u32 s78, s77, 4096
    s_mul_i32 s6, s4, 96
    s_add_u32 s6, s6, 4108
    s_add_u32 s7, s6, s5
    s_lshl_b32 s81, s7, 10
    s_lshr_b32 s4, s44, 1
    s_xor_b32 s4, s4, 1
    s_lshl_b32 s6, s45, 1
    s_add_u32 s4, s4, s6
    s_lshl_b32 s6, s4, 5
    s_lshl_b32 s7, s44, 3
    s_add_u32 s6, s6, s7
    s_lshl_b32 s6, s6, 10
    s_add_u32 s79, s6, 4096
    s_add_u32 s80, s79, 4096
    s_mul_i32 s6, s4, 96
    s_add_u32 s6, s6, 4108
    s_add_u32 s7, s6, s5
    s_lshl_b32 s82, s7, 10
    s_lshl_b32 s4, s45, 1
    s_lshr_b32 s6, s44, 1
    s_add_u32 s4, s4, s6
    s_lshl_b32 s6, s46, 1
    s_and_b32 s7, s44, 1
    s_add_u32 s6, s6, s7
    v_and_b32 v24, 31, v1
    v_lshlrev_b32 v24, 10, v24
    v_lshrrev_b32 v25, 5, v1
    v_lshl_add_u32 v24, v25, 4, v24
    s_lshl_b32 s7, s4, 15
    v_add_u32 v24, s7, v24
    s_lshl_b32 s7, s6, 6
    v_add_u32 v27, s7, v24
    s_lshl_b32 s4, s4, 4
    s_add_u32 s4, s4, s6
    s_lshl_b32 s6, s4, 11
    s_add_u32 s83, s6, 2105344
    s_lshl_b32 s6, s4, 8
    s_add_u32 s84, s6, 10502144
    s_lshl_b32 s6, s4, 3
    s_add_u32 s85, s6, 11345920
    v_lshrrev_b32 v24, 5, v1
    v_lshlrev_b32 v24, 10, v24
    v_bfe_u32 v25, v1, 2, 2
    v_lshl_add_u32 v24, v25, 7, v24
    v_bfe_u32 v25, v1, 3, 1
    s_and_b32 s4, s44, 1
    v_xor_b32 v25, s4, v25
    v_lshl_add_u32 v24, v25, 6, v24
    v_bfe_u32 v25, v1, 4, 1
    v_lshl_add_u32 v24, v25, 5, v24
    v_and_b32 v25, 1, v1
    v_lshl_add_u32 v24, v25, 4, v24
    v_bfe_u32 v25, v1, 1, 1
    v_lshl_add_u32 v24, v25, 3, v24
    v_mov_b32 v32, v24
    s_lshl_b32 s4, s47, 2
    s_add_u32 s4, s4, s44
    s_lshl_b32 s6, s4, 15
    s_add_u32 s86, s6, 2105344
    s_lshl_b32 s6, s4, 12
    s_add_u32 s87, s6, 10502144
    s_mul_i32 s6, s4, 96
    s_mul_i32 s7, s68, 6
    s_add_u32 s6, s6, s7
    s_lshl_b32 s6, s6, 10
    s_add_u32 s88, s6, 4206592
    s_mul_i32 s6, s4, 48
    s_add_u32 s6, s6, s68
    s_lshl_b32 s6, s6, 3
    s_add_u32 s89, s6, 11354112
    s_lshl_b32 s6, s4, 7
    s_add_u32 s6, s6, 11345920
    v_and_b32 v24, 15, v1
    v_lshl_add_u32 v34, v24, 3, s6
    s_lshl_b32 s4, s45, 5
    s_lshl_b32 s6, s44, 3
    s_add_u32 s4, s4, s6
    s_lshl_b32 s4, s4, 3
    s_add_u32 s4, s4, 11337728
    v_and_b32 v24, 7, v1
    v_lshl_add_u32 v33, v24, 3, s4
    s_lshr_b32 s7, s44, 1
    s_sub_u32 s6, 7, s7
    v_min_u32 v24, s6, v24
    v_lshlrev_b32 v24, 4, v24
    v_bfe_u32 v25, v1, 3, 1
    v_mul_u32_u24 v25, 384, v25
    s_mul_i32 s4, s45, 96
    s_add_u32 s4, s4, s7
    s_lshl_b32 s4, s4, 3
    s_add_u32 s4, s4, 11354112
    v_add3_u32 v35, v24, v25, s4
    v_lshrrev_b32 v24, 4, v1
    v_lshl_add_u32 v24, v24, 7, v35
    s_mov_b32 s6, 0
    s_mov_b32 s7, 0x00ff0000
    v_cndmask_b32 v24, v24, v34, s[6:7]
    s_mov_b32 s7, 0xff000000
    v_cndmask_b32 v24, v24, v33, s[6:7]
    v_mov_b32 v36, v24
    v_bfe_u32 v24, v1, 1, 3
    v_lshrrev_b32 v25, 4, v1
    v_xor_b32 v24, v24, v25
    v_lshlrev_b32 v24, 4, v24
    v_and_b32 v26, 15, v1
    v_lshl_add_u32 v37, v26, 7, v24
    v_xor_b32 v38, 64, v37
    v_bfe_u32 v24, v1, 3, 2
    v_xor_b32 v24, s44, v24
    v_lshlrev_b32 v24, 5, v24
    v_mul_u32_u24 v25, 3072, v25
    v_bfe_u32 v26, v1, 2, 2
    v_lshl_add_u32 v24, v26, 7, v24
    v_and_b32 v26, 3, v1
    v_lshl_add_u32 v24, v26, 3, v24
    v_add_u32 v39, v24, v25
    v_and_b32 v24, 15, v1
    v_lshrrev_b32 v25, 4, v1
    v_lshlrev_b32 v56, 2, v24
    v_add_u32 v56, 155648, v56
    v_lshlrev_b32 v57, 4, v25
    v_add_u32 v57, 155648, v57
    v_lshlrev_b32 v25, 2, v25
    v_sub_u32 v24, v24, v25
    v_mov_b32 v26, 0xf149f2ca
    s_cmp_eq_u32 s45, 0
    s_cselect_b64 s[58:59], 0, -1
    v_subrev_u32 v25, 0, v24
    v_and_b32 v25, 0x80000001, v25
    v_cmp_eq_u32 vcc, 0, v25
    s_nop 1
    v_cndmask_b32 v40, v26, 0, vcc
    v_cmp_eq_u32 vcc, 0x80000000, v25
    s_nop 1
    v_cndmask_b32 v44, v26, 0, vcc
    v_cndmask_b32 v48, v26, v44, s[58:59]
    v_subrev_u32 v25, 1, v24
    v_and_b32 v25, 0x80000001, v25
    v_cmp_eq_u32 vcc, 0, v25
    s_nop 1
    v_cndmask_b32 v41, v26, 0, vcc
    v_cmp_eq_u32 vcc, 0x80000000, v25
    s_nop 1
    v_cndmask_b32 v45, v26, 0, vcc
    v_cndmask_b32 v49, v26, v45, s[58:59]
    v_subrev_u32 v25, 2, v24
    v_and_b32 v25, 0x80000001, v25
    v_cmp_eq_u32 vcc, 0, v25
    s_nop 1
    v_cndmask_b32 v42, v26, 0, vcc
    v_cmp_eq_u32 vcc, 0x80000000, v25
    s_nop 1
    v_cndmask_b32 v46, v26, 0, vcc
    v_cndmask_b32 v50, v26, v46, s[58:59]
    v_subrev_u32 v25, 3, v24
    v_and_b32 v25, 0x80000001, v25
    v_cmp_eq_u32 vcc, 0, v25
    s_nop 1
    v_cndmask_b32 v43, v26, 0, vcc
    v_cmp_eq_u32 vcc, 0x80000000, v25
    s_nop 1
    v_cndmask_b32 v47, v26, 0, vcc
    v_cndmask_b32 v51, v26, v47, s[58:59]
    v_ashrrev_i32 v24, 31, v44
    v_ashrrev_i32 v25, 31, v45
    v_and_b32 v24, 0xffff, v24
    v_and_b32 v25, 0xffff0000, v25
    v_or_b32 v24, v24, v25
    v_not_b32 v52, v24
    v_ashrrev_i32 v24, 31, v46
    v_ashrrev_i32 v25, 31, v47
    v_and_b32 v24, 0xffff, v24
    v_and_b32 v25, 0xffff0000, v25
    v_or_b32 v24, v24, v25
    v_not_b32 v53, v24
    v_ashrrev_i32 v24, 31, v40
    v_ashrrev_i32 v25, 31, v41
    v_and_b32 v24, 0xffff, v24
    v_and_b32 v25, 0xffff0000, v25
    v_or_b32 v24, v24, v25
    v_not_b32 v54, v24
    v_ashrrev_i32 v24, 31, v42
    v_ashrrev_i32 v25, 31, v43
    v_and_b32 v24, 0xffff, v24
    v_and_b32 v25, 0xffff0000, v25
    v_or_b32 v24, v24, v25
    v_not_b32 v55, v24
    s_mov_b32 s60, 0x3b000000
    s_mov_b32 s61, 0x3eb8aa3b
    buffer_load_dword v36, v36, s[40:43], 0 offen sc1
    s_mov_b32 s53, 0
    s_nop 0
L_lw_48:
    ds_read_b32 v58, v8 offset:352
    s_add_u32 s53, s53, 1
    s_cmp_gt_u32 s53, 1048576
    s_cbranch_scc1 L_lg_49
    s_waitcnt lgkmcnt(0)
    v_cmp_eq_u32 vcc, 0, v58
    s_nop 0
    s_cbranch_vccnz L_lw_48
    s_nop 2
L_lg_49:
    ds_read_b64_tr_b16 v[80:81], v39 offset:10240
    ds_read_b64_tr_b16 v[82:83], v39 offset:10752
    ds_read_b128 v[60:63], v37 offset:0
    ds_read_b128 v[64:67], v37 offset:2048
    ds_read_b128 v[68:71], v37 offset:4096
    ds_read_b128 v[72:75], v37 offset:6144
    ds_read_b128 v[76:79], v37 offset:8192
    ds_read_b64_tr_b16 v[84:85], v39 offset:11264
    ds_read_b64_tr_b16 v[86:87], v39 offset:11776
    ds_read_b64_tr_b16 v[88:89], v39 offset:12288
    ds_read_b64_tr_b16 v[90:91], v39 offset:12800
    ds_read_b32 v58, v8 offset:368
    s_waitcnt lgkmcnt(9)
    v_mfma_f32_16x16x32_bf16 v[124:127], v[80:83], v[60:63], 0
    s_waitcnt lgkmcnt(0)
    v_cmp_eq_u32 vcc, 0, v58
    s_nop 0
    s_cbranch_vccnz L_ls_50
L_lb_51:
    v_mfma_f32_16x16x32_bf16 v[128:131], v[80:83], v[64:67], 0
    ds_read_b64_tr_b16 v[112:113], v39 offset:22528
    ds_read_b64_tr_b16 v[114:115], v39 offset:23040
    v_mfma_f32_16x16x32_bf16 v[132:135], v[80:83], v[68:71], 0
    ds_read_b128 v[92:95], v38 offset:0
    ds_read_b128 v[96:99], v38 offset:2048
    v_mfma_f32_16x16x32_bf16 v[136:139], v[80:83], v[72:75], 0
    ds_read_b128 v[100:103], v38 offset:4096
    ds_read_b128 v[104:107], v38 offset:6144
    v_mfma_f32_16x16x32_bf16 v[140:143], v[80:83], v[76:79], 0
    ds_read_b128 v[108:111], v38 offset:8192
    ds_read_b64_tr_b16 v[116:117], v39 offset:23552
    v_mfma_f32_16x16x32_bf16 v[144:147], v[84:87], v[60:63], 0
    ds_read_b64_tr_b16 v[118:119], v39 offset:24064
    ds_read_b64_tr_b16 v[120:121], v39 offset:24576
    v_mfma_f32_16x16x32_bf16 v[148:151], v[84:87], v[64:67], 0
    ds_read_b64_tr_b16 v[122:123], v39 offset:25088
    ds_write_b32 v6, v6 offset:496
    v_mfma_f32_16x16x32_bf16 v[152:155], v[84:87], v[68:71], 0
    v_mfma_f32_16x16x32_bf16 v[156:159], v[84:87], v[72:75], 0
    v_mfma_f32_16x16x32_bf16 v[160:163], v[84:87], v[76:79], 0
    v_mfma_f32_16x16x32_bf16 v[164:167], v[60:63], v[88:91], 0
    v_mfma_f32_16x16x32_bf16 v[168:171], v[64:67], v[88:91], 0
    ds_read_b32 v58, v8 offset:656
    v_mfma_f32_16x16x32_bf16 v[172:175], v[68:71], v[88:91], 0
    v_mfma_f32_16x16x32_bf16 v[176:179], v[72:75], v[88:91], 0
    v_mfma_f32_16x16x32_bf16 v[180:183], v[76:79], v[88:91], 0
    s_waitcnt lgkmcnt(10)
    v_mfma_f32_16x16x32_bf16 v[124:127], v[112:115], v[92:95], v[124:127]
    s_waitcnt lgkmcnt(0)
    v_cmp_eq_u32 vcc, 0, v58
    s_nop 0
    s_cbranch_vccnz L_ls_53
L_lb_54:
    v_mfma_f32_16x16x32_bf16 v[128:131], v[112:115], v[96:99], v[128:131]
    v_add_u32 v39, 34816, v39
    v_add_u32 v37, 34816, v37
    v_mfma_f32_16x16x32_bf16 v[132:135], v[112:115], v[100:103], v[132:135]
    v_add_u32 v38, 34816, v38
    ds_read_b64_tr_b16 v[80:81], v39 offset:10240
    v_mfma_f32_16x16x32_bf16 v[136:139], v[112:115], v[104:107], v[136:139]
    ds_read_b64_tr_b16 v[82:83], v39 offset:10752
    ds_read_b128 v[60:63], v37 offset:0
    v_mfma_f32_16x16x32_bf16 v[140:143], v[112:115], v[108:111], v[140:143]
    ds_read_b128 v[64:67], v37 offset:2048
    ds_read_b128 v[68:71], v37 offset:4096
    v_mfma_f32_16x16x32_bf16 v[144:147], v[116:119], v[92:95], v[144:147]
    ds_read_b128 v[72:75], v37 offset:6144
    ds_read_b128 v[76:79], v37 offset:8192
    v_mfma_f32_16x16x32_bf16 v[148:151], v[116:119], v[96:99], v[148:151]
    ds_read_b64_tr_b16 v[84:85], v39 offset:11264
    ds_read_b64_tr_b16 v[86:87], v39 offset:11776
    v_mfma_f32_16x16x32_bf16 v[152:155], v[116:119], v[100:103], v[152:155]
    ds_read_b64_tr_b16 v[88:89], v39 offset:12288
    ds_read_b64_tr_b16 v[90:91], v39 offset:12800
    v_mfma_f32_16x16x32_bf16 v[156:159], v[116:119], v[104:107], v[156:159]
    v_mfma_f32_16x16x32_bf16 v[160:163], v[116:119], v[108:111], v[160:163]
    v_mfma_f32_16x16x32_bf16 v[164:167], v[92:95], v[120:123], v[164:167]
    v_mfma_f32_16x16x32_bf16 v[168:171], v[96:99], v[120:123], v[168:171]
    ds_read_b32 v58, v8 offset:384
    v_mfma_f32_16x16x32_bf16 v[172:175], v[100:103], v[120:123], v[172:175]
    v_mfma_f32_16x16x32_bf16 v[176:179], v[104:107], v[120:123], v[176:179]
    v_mfma_f32_16x16x32_bf16 v[180:183], v[108:111], v[120:123], v[180:183]
    s_waitcnt lgkmcnt(9)
    v_mfma_f32_16x16x32_bf16 v[124:127], v[80:83], v[60:63], v[124:127]
    s_waitcnt lgkmcnt(0)
    v_cmp_eq_u32 vcc, 0, v58
    s_nop 0
    s_cbranch_vccnz L_ls_56
L_lb_57:
    v_mfma_f32_16x16x32_bf16 v[128:131], v[80:83], v[64:67], v[128:131]
    ds_read_b64_tr_b16 v[112:113], v39 offset:22528
    ds_read_b64_tr_b16 v[114:115], v39 offset:23040
    v_mfma_f32_16x16x32_bf16 v[132:135], v[80:83], v[68:71], v[132:135]
    ds_read_b128 v[92:95], v38 offset:0
    ds_read_b128 v[96:99], v38 offset:2048
    v_mfma_f32_16x16x32_bf16 v[136:139], v[80:83], v[72:75], v[136:139]
    ds_read_b128 v[100:103], v38 offset:4096
    ds_read_b128 v[104:107], v38 offset:6144
    v_mfma_f32_16x16x32_bf16 v[140:143], v[80:83], v[76:79], v[140:143]
    ds_read_b128 v[108:111], v38 offset:8192
    ds_read_b64_tr_b16 v[116:117], v39 offset:23552
    v_mfma_f32_16x16x32_bf16 v[144:147], v[84:87], v[60:63], v[144:147]
    ds_read_b64_tr_b16 v[118:119], v39 offset:24064
    ds_read_b64_tr_b16 v[120:121], v39 offset:24576
    v_mfma_f32_16x16x32_bf16 v[148:151], v[84:87], v[64:67], v[148:151]
    ds_read_b64_tr_b16 v[122:123], v39 offset:25088
    ds_write_b32 v6, v6 offset:512
    v_mfma_f32_16x16x32_bf16 v[152:155], v[84:87], v[68:71], v[152:155]
    v_mfma_f32_16x16x32_bf16 v[156:159], v[84:87], v[72:75], v[156:159]
    v_mfma_f32_16x16x32_bf16 v[160:163], v[84:87], v[76:79], v[160:163]
    v_mfma_f32_16x16x32_bf16 v[164:167], v[60:63], v[88:91], v[164:167]
    v_mfma_f32_16x16x32_bf16 v[168:171], v[64:67], v[88:91], v[168:171]
    ds_read_b32 v58, v8 offset:672
    v_mfma_f32_16x16x32_bf16 v[172:175], v[68:71], v[88:91], v[172:175]
    v_mfma_f32_16x16x32_bf16 v[176:179], v[72:75], v[88:91], v[176:179]
    v_mfma_f32_16x16x32_bf16 v[180:183], v[76:79], v[88:91], v[180:183]
    s_waitcnt lgkmcnt(10)
    v_mfma_f32_16x16x32_bf16 v[124:127], v[112:115], v[92:95], v[124:127]
    s_waitcnt lgkmcnt(0)
    v_cmp_eq_u32 vcc, 0, v58
    s_nop 0
    s_cbranch_vccnz L_ls_59
L_lb_60:
    v_mfma_f32_16x16x32_bf16 v[128:131], v[112:115], v[96:99], v[128:131]
    v_add_u32 v39, 34816, v39
    v_add_u32 v37, 34816, v37
    v_mfma_f32_16x16x32_bf16 v[132:135], v[112:115], v[100:103], v[132:135]
    v_add_u32 v38, 34816, v38
    ds_read_b64_tr_b16 v[80:81], v39 offset:10240
    v_mfma_f32_16x16x32_bf16 v[136:139], v[112:115], v[104:107], v[136:139]
    ds_read_b64_tr_b16 v[82:83], v39 offset:10752
    ds_read_b128 v[60:63], v37 offset:0
    v_mfma_f32_16x16x32_bf16 v[140:143], v[112:115], v[108:111], v[140:143]
    ds_read_b128 v[64:67], v37 offset:2048
    ds_read_b128 v[68:71], v37 offset:4096
    v_mfma_f32_16x16x32_bf16 v[144:147], v[116:119], v[92:95], v[144:147]
    ds_read_b128 v[72:75], v37 offset:6144
    ds_read_b128 v[76:79], v37 offset:8192
    v_mfma_f32_16x16x32_bf16 v[148:151], v[116:119], v[96:99], v[148:151]
    ds_read_b64_tr_b16 v[84:85], v39 offset:11264
    ds_read_b64_tr_b16 v[86:87], v39 offset:11776
    v_mfma_f32_16x16x32_bf16 v[152:155], v[116:119], v[100:103], v[152:155]
    ds_read_b64_tr_b16 v[88:89], v39 offset:12288
    ds_read_b64_tr_b16 v[90:91], v39 offset:12800
    v_mfma_f32_16x16x32_bf16 v[156:159], v[116:119], v[104:107], v[156:159]
    v_mfma_f32_16x16x32_bf16 v[160:163], v[116:119], v[108:111], v[160:163]
    v_mfma_f32_16x16x32_bf16 v[164:167], v[92:95], v[120:123], v[164:167]
    v_mfma_f32_16x16x32_bf16 v[168:171], v[96:99], v[120:123], v[168:171]
    ds_read_b32 v58, v8 offset:400
    v_mfma_f32_16x16x32_bf16 v[172:175], v[100:103], v[120:123], v[172:175]
    v_mfma_f32_16x16x32_bf16 v[176:179], v[104:107], v[120:123], v[176:179]
    v_mfma_f32_16x16x32_bf16 v[180:183], v[108:111], v[120:123], v[180:183]
    s_waitcnt lgkmcnt(9)
    v_mfma_f32_16x16x32_bf16 v[124:127], v[80:83], v[60:63], v[124:127]
    s_waitcnt lgkmcnt(0)
    v_cmp_eq_u32 vcc, 0, v58
    s_nop 0
    s_cbranch_vccnz L_ls_62
L_lb_63:
    v_mfma_f32_16x16x32_bf16 v[128:131], v[80:83], v[64:67], v[128:131]
    ds_read_b64_tr_b16 v[112:113], v39 offset:22528
    ds_read_b64_tr_b16 v[114:115], v39 offset:23040
    v_mfma_f32_16x16x32_bf16 v[132:135], v[80:83], v[68:71], v[132:135]
    ds_read_b128 v[92:95], v38 offset:0
    ds_read_b128 v[96:99], v38 offset:2048
    v_mfma_f32_16x16x32_bf16 v[136:139], v[80:83], v[72:75], v[136:139]
    ds_read_b128 v[100:103], v38 offset:4096
    ds_read_b128 v[104:107], v38 offset:6144
    v_mfma_f32_16x16x32_bf16 v[140:143], v[80:83], v[76:79], v[140:143]
    ds_read_b128 v[108:111], v38 offset:8192
    ds_read_b64_tr_b16 v[116:117], v39 offset:23552
    v_mfma_f32_16x16x32_bf16 v[144:147], v[84:87], v[60:63], v[144:147]
    ds_read_b64_tr_b16 v[118:119], v39 offset:24064
    ds_read_b64_tr_b16 v[120:121], v39 offset:24576
    v_mfma_f32_16x16x32_bf16 v[148:151], v[84:87], v[64:67], v[148:151]
    ds_read_b64_tr_b16 v[122:123], v39 offset:25088
    ds_write_b32 v6, v6 offset:528
    v_mfma_f32_16x16x32_bf16 v[152:155], v[84:87], v[68:71], v[152:155]
    v_mfma_f32_16x16x32_bf16 v[156:159], v[84:87], v[72:75], v[156:159]
    v_mfma_f32_16x16x32_bf16 v[160:163], v[84:87], v[76:79], v[160:163]
    v_mfma_f32_16x16x32_bf16 v[164:167], v[60:63], v[88:91], v[164:167]
    v_mfma_f32_16x16x32_bf16 v[168:171], v[64:67], v[88:91], v[168:171]
    ds_read_b32 v58, v8 offset:416
    v_mfma_f32_16x16x32_bf16 v[172:175], v[68:71], v[88:91], v[172:175]
    v_mfma_f32_16x16x32_bf16 v[176:179], v[72:75], v[88:91], v[176:179]
    v_mfma_f32_16x16x32_bf16 v[180:183], v[76:79], v[88:91], v[180:183]
    s_waitcnt lgkmcnt(10)
    v_mfma_f32_16x16x32_bf16 v[124:127], v[112:115], v[92:95], v[124:127]
    s_waitcnt lgkmcnt(0)
    v_cmp_eq_u32 vcc, 0, v58
    s_nop 0
    s_cbranch_vccnz L_ls_65
L_lb_66:
    v_mfma_f32_16x16x32_bf16 v[128:131], v[112:115], v[96:99], v[128:131]
    v_add_u32 v39, 34816, v39
    v_add_u32 v37, 34816, v37
    v_mfma_f32_16x16x32_bf16 v[132:135], v[112:115], v[100:103], v[132:135]
    v_add_u32 v38, 34816, v38
    ds_read_b64_tr_b16 v[80:81], v39 offset:10240
    v_mfma_f32_16x16x32_bf16 v[136:139], v[112:115], v[104:107], v[136:139]
    ds_read_b64_tr_b16 v[82:83], v39 offset:10752
    ds_read_b128 v[60:63], v37 offset:0
    v_mfma_f32_16x16x32_bf16 v[140:143], v[112:115], v[108:111], v[140:143]
    ds_read_b128 v[64:67], v37 offset:2048
    ds_read_b128 v[68:71], v37 offset:4096
    v_mfma_f32_16x16x32_bf16 v[144:147], v[116:119], v[92:95], v[144:147]
    ds_read_b128 v[72:75], v37 offset:6144
    ds_read_b128 v[76:79], v37 offset:8192
    v_mfma_f32_16x16x32_bf16 v[148:151], v[116:119], v[96:99], v[148:151]
    ds_read_b64_tr_b16 v[84:85], v39 offset:11264
    ds_read_b64_tr_b16 v[86:87], v39 offset:11776
    v_mfma_f32_16x16x32_bf16 v[152:155], v[116:119], v[100:103], v[152:155]
    ds_read_b64_tr_b16 v[88:89], v39 offset:12288
    ds_read_b64_tr_b16 v[90:91], v39 offset:12800
    v_mfma_f32_16x16x32_bf16 v[156:159], v[116:119], v[104:107], v[156:159]
    v_mfma_f32_16x16x32_bf16 v[160:163], v[116:119], v[108:111], v[160:163]
    v_mfma_f32_16x16x32_bf16 v[164:167], v[92:95], v[120:123], v[164:167]
    v_mfma_f32_16x16x32_bf16 v[168:171], v[96:99], v[120:123], v[168:171]
    v_mfma_f32_16x16x32_bf16 v[172:175], v[100:103], v[120:123], v[172:175]
    v_mfma_f32_16x16x32_bf16 v[176:179], v[104:107], v[120:123], v[176:179]
    v_mfma_f32_16x16x32_bf16 v[180:183], v[108:111], v[120:123], v[180:183]
    s_waitcnt lgkmcnt(8)
    v_mfma_f32_16x16x32_bf16 v[124:127], v[80:83], v[60:63], v[124:127]
    ds_read_b64_tr_b16 v[112:113], v39 offset:22528
    ds_read_b64_tr_b16 v[114:115], v39 offset:23040
    s_waitcnt lgkmcnt(9)
    v_mfma_f32_16x16x32_bf16 v[128:131], v[80:83], v[64:67], v[128:131]
    ds_read_b128 v[92:95], v38 offset:0
    ds_read_b128 v[96:99], v38 offset:2048
    s_waitcnt lgkmcnt(10)
    v_mfma_f32_16x16x32_bf16 v[132:135], v[80:83], v[68:71], v[132:135]
    ds_read_b128 v[100:103], v38 offset:4096
    ds_read_b128 v[104:107], v38 offset:6144
    s_waitcnt lgkmcnt(11)
    v_mfma_f32_16x16x32_bf16 v[136:139], v[80:83], v[72:75], v[136:139]
    ds_read_b128 v[108:111], v38 offset:8192
    ds_read_b64_tr_b16 v[116:117], v39 offset:23552
    s_waitcnt lgkmcnt(12)
    v_mfma_f32_16x16x32_bf16 v[140:143], v[80:83], v[76:79], v[140:143]
    ds_read_b64_tr_b16 v[118:119], v39 offset:24064
    ds_read_b64_tr_b16 v[120:121], v39 offset:24576
    s_waitcnt lgkmcnt(12)
    v_mfma_f32_16x16x32_bf16 v[144:147], v[84:87], v[60:63], v[144:147]
    ds_read_b64_tr_b16 v[122:123], v39 offset:25088
    ds_write_b32 v6, v6 offset:544
    v_mfma_f32_16x16x32_bf16 v[148:151], v[84:87], v[64:67], v[148:151]
    v_mfma_f32_16x16x32_bf16 v[152:155], v[84:87], v[68:71], v[152:155]
    v_mfma_f32_16x16x32_bf16 v[156:159], v[84:87], v[72:75], v[156:159]
    v_mfma_f32_16x16x32_bf16 v[160:163], v[84:87], v[76:79], v[160:163]
    s_waitcnt lgkmcnt(12)
    v_mfma_f32_16x16x32_bf16 v[164:167], v[60:63], v[88:91], v[164:167]
    v_mfma_f32_16x16x32_bf16 v[168:171], v[64:67], v[88:91], v[168:171]
    ds_read_b32 v58, v8 offset:432
    v_mfma_f32_16x16x32_bf16 v[172:175], v[68:71], v[88:91], v[172:175]
    v_mfma_f32_16x16x32_bf16 v[176:179], v[72:75], v[88:91], v[176:179]
    v_mfma_f32_16x16x32_bf16 v[180:183], v[76:79], v[88:91], v[180:183]
    s_waitcnt lgkmcnt(10)
    v_mfma_f32_16x16x32_bf16 v[124:127], v[112:115], v[92:95], v[124:127]
    s_waitcnt lgkmcnt(0)
    v_cmp_eq_u32 vcc, 0, v58
    s_nop 0
    s_cbranch_vccnz L_ls_68
L_lb_69:
    v_mfma_f32_16x16x32_bf16 v[128:131], v[112:115], v[96:99], v[128:131]
    v_add_u32 v39, 4294862848, v39
    v_add_u32 v37, 4294862848, v37
    v_mfma_f32_16x16x32_bf16 v[132:135], v[112:115], v[100:103], v[132:135]
    v_add_u32 v38, 4294862848, v38
    ds_read_b64_tr_b16 v[80:81], v39 offset:10240
    v_mfma_f32_16x16x32_bf16 v[136:139], v[112:115], v[104:107], v[136:139]
    ds_read_b64_tr_b16 v[82:83], v39 offset:10752
    ds_read_b128 v[60:63], v37 offset:0
    v_mfma_f32_16x16x32_bf16 v[140:143], v[112:115], v[108:111], v[140:143]
    ds_read_b128 v[64:67], v37 offset:2048
    ds_read_b128 v[68:71], v37 offset:4096
    v_mfma_f32_16x16x32_bf16 v[144:147], v[116:119], v[92:95], v[144:147]
    ds_read_b128 v[72:75], v37 offset:6144
    ds_read_b128 v[76:79], v37 offset:8192
    v_mfma_f32_16x16x32_bf16 v[148:151], v[116:119], v[96:99], v[148:151]
    ds_read_b64_tr_b16 v[84:85], v39 offset:11264
    ds_read_b64_tr_b16 v[86:87], v39 offset:11776
    v_mfma_f32_16x16x32_bf16 v[152:155], v[116:119], v[100:103], v[152:155]
    ds_read_b64_tr_b16 v[88:89], v39 offset:12288
    ds_read_b64_tr_b16 v[90:91], v39 offset:12800
    v_mfma_f32_16x16x32_bf16 v[156:159], v[116:119], v[104:107], v[156:159]
    v_mfma_f32_16x16x32_bf16 v[160:163], v[116:119], v[108:111], v[160:163]
    v_mfma_f32_16x16x32_bf16 v[164:167], v[92:95], v[120:123], v[164:167]
    v_mfma_f32_16x16x32_bf16 v[168:171], v[96:99], v[120:123], v[168:171]
    v_mfma_f32_16x16x32_bf16 v[172:175], v[100:103], v[120:123], v[172:175]
    v_mfma_f32_16x16x32_bf16 v[176:179], v[104:107], v[120:123], v[176:179]
    v_mfma_f32_16x16x32_bf16 v[180:183], v[108:111], v[120:123], v[180:183]
    s_waitcnt lgkmcnt(8)
    v_mfma_f32_16x16x32_bf16 v[124:127], v[80:83], v[60:63], v[124:127]
    ds_read_b64_tr_b16 v[112:113], v39 offset:22528
    ds_read_b64_tr_b16 v[114:115], v39 offset:23040
    s_waitcnt lgkmcnt(9)
    v_mfma_f32_16x16x32_bf16 v[128:131], v[80:83], v[64:67], v[128:131]
    ds_read_b128 v[92:95], v38 offset:0
    ds_read_b128 v[96:99], v38 offset:2048
    s_waitcnt lgkmcnt(10)
    v_mfma_f32_16x16x32_bf16 v[132:135], v[80:83], v[68:71], v[132:135]
    ds_read_b128 v[100:103], v38 offset:4096
    ds_read_b128 v[104:107], v38 offset:6144
    s_waitcnt lgkmcnt(11)
    v_mfma_f32_16x16x32_bf16 v[136:139], v[80:83], v[72:75], v[136:139]
    ds_read_b128 v[108:111], v38 offset:8192
    ds_read_b64_tr_b16 v[116:117], v39 offset:23552
    s_waitcnt lgkmcnt(12)
    v_mfma_f32_16x16x32_bf16 v[140:143], v[80:83], v[76:79], v[140:143]
    ds_read_b64_tr_b16 v[118:119], v39 offset:24064
    ds_read_b64_tr_b16 v[120:121], v39 offset:24576
    s_waitcnt lgkmcnt(12)
    v_mfma_f32_16x16x32_bf16 v[144:147], v[84:87], v[60:63], v[144:147]
    ds_read_b64_tr_b16 v[122:123], v39 offset:25088
    v_mfma_f32_16x16x32_bf16 v[148:151], v[84:87], v[64:67], v[148:151]
    v_mfma_f32_16x16x32_bf16 v[152:155], v[84:87], v[68:71], v[152:155]
    v_mfma_f32_16x16x32_bf16 v[156:159], v[84:87], v[72:75], v[156:159]
    v_mfma_f32_16x16x32_bf16 v[160:163], v[84:87], v[76:79], v[160:163]
    s_waitcnt lgkmcnt(11)
    v_mfma_f32_16x16x32_bf16 v[164:167], v[60:63], v[88:91], v[164:167]
    v_mfma_f32_16x16x32_bf16 v[168:171], v[64:67], v[88:91], v[168:171]
    ds_read_b32 v58, v8 offset:448
    v_mfma_f32_16x16x32_bf16 v[172:175], v[68:71], v[88:91], v[172:175]
    v_mfma_f32_16x16x32_bf16 v[176:179], v[72:75], v[88:91], v[176:179]
    v_mfma_f32_16x16x32_bf16 v[180:183], v[76:79], v[88:91], v[180:183]
    s_waitcnt lgkmcnt(9)
    v_mfma_f32_16x16x32_bf16 v[124:127], v[112:115], v[92:95], v[124:127]
    s_waitcnt lgkmcnt(0)
    v_cmp_eq_u32 vcc, 0, v58
    s_nop 0
    s_cbranch_vccnz L_ls_71
L_lb_72:
    v_mfma_f32_16x16x32_bf16 v[128:131], v[112:115], v[96:99], v[128:131]
    v_add_u32 v39, 34816, v39
    v_add_u32 v37, 34816, v37
    v_mfma_f32_16x16x32_bf16 v[132:135], v[112:115], v[100:103], v[132:135]
    v_add_u32 v38, 34816, v38
    ds_read_b64_tr_b16 v[80:81], v39 offset:10240
    v_mfma_f32_16x16x32_bf16 v[136:139], v[112:115], v[104:107], v[136:139]
    ds_read_b64_tr_b16 v[82:83], v39 offset:10752
    ds_read_b128 v[60:63], v37 offset:0
    v_mfma_f32_16x16x32_bf16 v[140:143], v[112:115], v[108:111], v[140:143]
    ds_read_b128 v[64:67], v37 offset:2048
    ds_read_b128 v[68:71], v37 offset:4096
    v_mfma_f32_16x16x32_bf16 v[144:147], v[116:119], v[92:95], v[144:147]
    ds_read_b128 v[72:75], v37 offset:6144
    ds_read_b128 v[76:79], v37 offset:8192
    v_mfma_f32_16x16x32_bf16 v[148:151], v[116:119], v[96:99], v[148:151]
    ds_read_b64_tr_b16 v[84:85], v39 offset:11264
    ds_read_b64_tr_b16 v[86:87], v39 offset:11776
    v_mfma_f32_16x16x32_bf16 v[152:155], v[116:119], v[100:103], v[152:155]
    ds_read_b64_tr_b16 v[88:89], v39 offset:12288
    ds_read_b64_tr_b16 v[90:91], v39 offset:12800
    v_mfma_f32_16x16x32_bf16 v[156:159], v[116:119], v[104:107], v[156:159]
    v_mfma_f32_16x16x32_bf16 v[160:163], v[116:119], v[108:111], v[160:163]
    v_mfma_f32_16x16x32_bf16 v[164:167], v[92:95], v[120:123], v[164:167]
    v_mfma_f32_16x16x32_bf16 v[168:171], v[96:99], v[120:123], v[168:171]
    v_mfma_f32_16x16x32_bf16 v[172:175], v[100:103], v[120:123], v[172:175]
    v_mfma_f32_16x16x32_bf16 v[176:179], v[104:107], v[120:123], v[176:179]
    v_mfma_f32_16x16x32_bf16 v[180:183], v[108:111], v[120:123], v[180:183]
    s_waitcnt lgkmcnt(8)
    v_mfma_f32_16x16x32_bf16 v[124:127], v[80:83], v[60:63], v[124:127]
    ds_read_b64_tr_b16 v[112:113], v39 offset:22528
    ds_read_b64_tr_b16 v[114:115], v39 offset:23040
    s_waitcnt lgkmcnt(9)
    v_mfma_f32_16x16x32_bf16 v[128:131], v[80:83], v[64:67], v[128:131]
    ds_read_b128 v[92:95], v38 offset:0
    ds_read_b128 v[96:99], v38 offset:2048
    s_waitcnt lgkmcnt(10)
    v_mfma_f32_16x16x32_bf16 v[132:135], v[80:83], v[68:71], v[132:135]
    ds_read_b128 v[100:103], v38 offset:4096
    ds_read_b128 v[104:107], v38 offset:6144
    s_waitcnt lgkmcnt(11)
    v_mfma_f32_16x16x32_bf16 v[136:139], v[80:83], v[72:75], v[136:139]
    ds_read_b128 v[108:111], v38 offset:8192
    ds_read_b64_tr_b16 v[116:117], v39 offset:23552
    s_waitcnt lgkmcnt(12)
    v_mfma_f32_16x16x32_bf16 v[140:143], v[80:83], v[76:79], v[140:143]
    ds_read_b64_tr_b16 v[118:119], v39 offset:24064
    ds_read_b64_tr_b16 v[120:121], v39 offset:24576
    s_waitcnt lgkmcnt(12)
    v_mfma_f32_16x16x32_bf16 v[144:147], v[84:87], v[60:63], v[144:147]
    ds_read_b64_tr_b16 v[122:123], v39 offset:25088
    v_mfma_f32_16x16x32_bf16 v[148:151], v[84:87], v[64:67], v[148:151]
    v_mfma_f32_16x16x32_bf16 v[152:155], v[84:87], v[68:71], v[152:155]
    v_mfma_f32_16x16x32_bf16 v[156:159], v[84:87], v[72:75], v[156:159]
    v_mfma_f32_16x16x32_bf16 v[160:163], v[84:87], v[76:79], v[160:163]
    s_waitcnt lgkmcnt(11)
    v_mfma_f32_16x16x32_bf16 v[164:167], v[60:63], v[88:91], v[164:167]
    v_mfma_f32_16x16x32_bf16 v[168:171], v[64:67], v[88:91], v[168:171]
    ds_read_b32 v58, v8 offset:464
    v_mfma_f32_16x16x32_bf16 v[172:175], v[68:71], v[88:91], v[172:175]
    v_mfma_f32_16x16x32_bf16 v[176:179], v[72:75], v[88:91], v[176:179]
    v_mfma_f32_16x16x32_bf16 v[180:183], v[76:79], v[88:91], v[180:183]
    s_waitcnt lgkmcnt(9)
    v_mfma_f32_16x16x32_bf16 v[124:127], v[112:115], v[92:95], v[124:127]
    s_waitcnt lgkmcnt(0)
    v_cmp_eq_u32 vcc, 0, v58
    s_nop 0
    s_cbranch_vccnz L_ls_74
L_lb_75:
    v_mfma_f32_16x16x32_bf16 v[128:131], v[112:115], v[96:99], v[128:131]
    v_add_u32 v39, 34816, v39
    v_add_u32 v37, 34816, v37
    v_mfma_f32_16x16x32_bf16 v[132:135], v[112:115], v[100:103], v[132:135]
    v_add_u32 v38, 34816, v38
    ds_read_b64_tr_b16 v[80:81], v39 offset:10240
    v_mfma_f32_16x16x32_bf16 v[136:139], v[112:115], v[104:107], v[136:139]
    ds_read_b64_tr_b16 v[82:83], v39 offset:10752
    ds_read_b128 v[60:63], v37 offset:0
    v_mfma_f32_16x16x32_bf16 v[140:143], v[112:115], v[108:111], v[140:143]
    ds_read_b128 v[64:67], v37 offset:2048
    ds_read_b128 v[68:71], v37 offset:4096
    v_mfma_f32_16x16x32_bf16 v[144:147], v[116:119], v[92:95], v[144:147]
    ds_read_b128 v[72:75], v37 offset:6144
    ds_read_b128 v[76:79], v37 offset:8192
    v_mfma_f32_16x16x32_bf16 v[148:151], v[116:119], v[96:99], v[148:151]
    ds_read_b64_tr_b16 v[84:85], v39 offset:11264
    ds_read_b64_tr_b16 v[86:87], v39 offset:11776
    v_mfma_f32_16x16x32_bf16 v[152:155], v[116:119], v[100:103], v[152:155]
    ds_read_b64_tr_b16 v[88:89], v39 offset:12288
    ds_read_b64_tr_b16 v[90:91], v39 offset:12800
    v_mfma_f32_16x16x32_bf16 v[156:159], v[116:119], v[104:107], v[156:159]
    v_mfma_f32_16x16x32_bf16 v[160:163], v[116:119], v[108:111], v[160:163]
    v_mfma_f32_16x16x32_bf16 v[164:167], v[92:95], v[120:123], v[164:167]
    v_mfma_f32_16x16x32_bf16 v[168:171], v[96:99], v[120:123], v[168:171]
    v_mfma_f32_16x16x32_bf16 v[172:175], v[100:103], v[120:123], v[172:175]
    v_mfma_f32_16x16x32_bf16 v[176:179], v[104:107], v[120:123], v[176:179]
    v_mfma_f32_16x16x32_bf16 v[180:183], v[108:111], v[120:123], v[180:183]
    s_waitcnt lgkmcnt(8)
    v_mfma_f32_16x16x32_bf16 v[124:127], v[80:83], v[60:63], v[124:127]
    ds_read_b64_tr_b16 v[112:113], v39 offset:22528
    ds_read_b64_tr_b16 v[114:115], v39 offset:23040
    s_waitcnt lgkmcnt(9)
    v_mfma_f32_16x16x32_bf16 v[128:131], v[80:83], v[64:67], v[128:131]
    ds_read_b128 v[92:95], v38 offset:0
    ds_read_b128 v[96:99], v38 offset:2048
    s_waitcnt lgkmcnt(10)
    v_mfma_f32_16x16x32_bf16 v[132:135], v[80:83], v[68:71], v[132:135]
    ds_read_b128 v[100:103], v38 offset:4096
    ds_read_b128 v[104:107], v38 offset:6144
    s_waitcnt lgkmcnt(11)
    v_mfma_f32_16x16x32_bf16 v[136:139], v[80:83], v[72:75], v[136:139]
    ds_read_b128 v[108:111], v38 offset:8192
    ds_read_b64_tr_b16 v[116:117], v39 offset:23552
    s_waitcnt lgkmcnt(12)
    v_mfma_f32_16x16x32_bf16 v[140:143], v[80:83], v[76:79], v[140:143]
    ds_read_b64_tr_b16 v[118:119], v39 offset:24064
    ds_read_b64_tr_b16 v[120:121], v39 offset:24576
    s_waitcnt lgkmcnt(12)
    v_mfma_f32_16x16x32_bf16 v[144:147], v[84:87], v[60:63], v[144:147]
    ds_read_b64_tr_b16 v[122:123], v39 offset:25088
    v_mfma_f32_16x16x32_bf16 v[148:151], v[84:87], v[64:67], v[148:151]
    v_mfma_f32_16x16x32_bf16 v[152:155], v[84:87], v[68:71], v[152:155]
    v_mfma_f32_16x16x32_bf16 v[156:159], v[84:87], v[72:75], v[156:159]
    v_mfma_f32_16x16x32_bf16 v[160:163], v[84:87], v[76:79], v[160:163]
    s_waitcnt lgkmcnt(11)
    v_mfma_f32_16x16x32_bf16 v[164:167], v[60:63], v[88:91], v[164:167]
    v_mfma_f32_16x16x32_bf16 v[168:171], v[64:67], v[88:91], v[168:171]
    ds_read_b32 v58, v8 offset:480
    v_mfma_f32_16x16x32_bf16 v[172:175], v[68:71], v[88:91], v[172:175]
    buffer_load_dwordx4 v[12:15], v27, s[8:11], 0 offen
    v_mfma_f32_16x16x32_bf16 v[176:179], v[72:75], v[88:91], v[176:179]
    buffer_load_dwordx4 v[16:19], v27, s[8:11], 0 offen offset:32
    v_mfma_f32_16x16x32_bf16 v[180:183], v[76:79], v[88:91], v[180:183]
    s_waitcnt lgkmcnt(9)
    v_mfma_f32_16x16x32_bf16 v[124:127], v[112:115], v[92:95], v[124:127]
    s_waitcnt lgkmcnt(0)
    v_cmp_eq_u32 vcc, 0, v58
    s_nop 0
    s_cbranch_vccnz L_ls_77
L_lb_78:
    v_mfma_f32_16x16x32_bf16 v[128:131], v[112:115], v[96:99], v[128:131]
    v_add_u32 v39, 34816, v39
    v_add_u32 v37, 34816, v37
    v_mfma_f32_16x16x32_bf16 v[132:135], v[112:115], v[100:103], v[132:135]
    v_add_u32 v38, 34816, v38
    ds_read_b64_tr_b16 v[80:81], v39 offset:10240
    v_mfma_f32_16x16x32_bf16 v[136:139], v[112:115], v[104:107], v[136:139]
    ds_read_b64_tr_b16 v[82:83], v39 offset:10752
    ds_read_b128 v[60:63], v37 offset:0
    v_mfma_f32_16x16x32_bf16 v[140:143], v[112:115], v[108:111], v[140:143]
    ds_read_b128 v[64:67], v37 offset:2048
    ds_read_b128 v[68:71], v37 offset:4096
    v_mfma_f32_16x16x32_bf16 v[144:147], v[116:119], v[92:95], v[144:147]
    ds_read_b128 v[72:75], v37 offset:6144
    ds_read_b128 v[76:79], v37 offset:8192
    v_mfma_f32_16x16x32_bf16 v[148:151], v[116:119], v[96:99], v[148:151]
    ds_read_b64_tr_b16 v[84:85], v39 offset:11264
    ds_read_b64_tr_b16 v[86:87], v39 offset:11776
    v_mfma_f32_16x16x32_bf16 v[152:155], v[116:119], v[100:103], v[152:155]
    ds_read_b64_tr_b16 v[88:89], v39 offset:12288
    ds_read_b64_tr_b16 v[90:91], v39 offset:12800
    v_mfma_f32_16x16x32_bf16 v[156:159], v[116:119], v[104:107], v[156:159]
    v_mfma_f32_16x16x32_bf16 v[160:163], v[116:119], v[108:111], v[160:163]
    v_mfma_f32_16x16x32_bf16 v[164:167], v[92:95], v[120:123], v[164:167]
    v_mfma_f32_16x16x32_bf16 v[168:171], v[96:99], v[120:123], v[168:171]
    v_mfma_f32_16x16x32_bf16 v[172:175], v[100:103], v[120:123], v[172:175]
    v_mfma_f32_16x16x32_bf16 v[176:179], v[104:107], v[120:123], v[176:179]
    v_mfma_f32_16x16x32_bf16 v[180:183], v[108:111], v[120:123], v[180:183]
    s_waitcnt lgkmcnt(8)
    v_mfma_f32_16x16x32_bf16 v[124:127], v[80:83], v[60:63], v[124:127]
    ds_read_b64_tr_b16 v[112:113], v39 offset:22528
    ds_read_b64_tr_b16 v[114:115], v39 offset:23040
    s_waitcnt lgkmcnt(9)
    v_mfma_f32_16x16x32_bf16 v[128:131], v[80:83], v[64:67], v[128:131]
    ds_read_b128 v[92:95], v38 offset:0
    ds_read_b128 v[96:99], v38 offset:2048
    s_waitcnt lgkmcnt(10)
    v_mfma_f32_16x16x32_bf16 v[132:135], v[80:83], v[68:71], v[132:135]
    ds_read_b128 v[100:103], v38 offset:4096
    ds_read_b128 v[104:107], v38 offset:6144
    s_waitcnt lgkmcnt(11)
    v_mfma_f32_16x16x32_bf16 v[136:139], v[80:83], v[72:75], v[136:139]
    ds_read_b128 v[108:111], v38 offset:8192
    ds_read_b64_tr_b16 v[116:117], v39 offset:23552
    s_waitcnt lgkmcnt(12)
    v_mfma_f32_16x16x32_bf16 v[140:143], v[80:83], v[76:79], v[140:143]
    ds_read_b64_tr_b16 v[118:119], v39 offset:24064
    ds_read_b64_tr_b16 v[120:121], v39 offset:24576
    s_waitcnt lgkmcnt(12)
    v_mfma_f32_16x16x32_bf16 v[144:147], v[84:87], v[60:63], v[144:147]
    ds_read_b64_tr_b16 v[122:123], v39 offset:25088
    ds_write_b32 v6, v6 offset:240
    v_mfma_f32_16x16x32_bf16 v[148:151], v[84:87], v[64:67], v[148:151]
    v_mfma_f32_16x16x32_bf16 v[152:155], v[84:87], v[68:71], v[152:155]
    v_mfma_f32_16x16x32_bf16 v[156:159], v[84:87], v[72:75], v[156:159]
    v_mfma_f32_16x16x32_bf16 v[160:163], v[84:87], v[76:79], v[160:163]
    s_waitcnt lgkmcnt(12)
    v_mfma_f32_16x16x32_bf16 v[164:167], v[60:63], v[88:91], v[164:167]
    ds_read_b32 v25, v8 offset:256
    v_mfma_f32_16x16x32_bf16 v[168:171], v[64:67], v[88:91], v[168:171]
    v_mfma_f32_16x16x32_bf16 v[172:175], v[68:71], v[88:91], v[172:175]
    v_mfma_f32_16x16x32_bf16 v[176:179], v[72:75], v[88:91], v[176:179]
    v_mfma_f32_16x16x32_bf16 v[180:183], v[76:79], v[88:91], v[180:183]
    s_waitcnt lgkmcnt(0)
    v_cmp_eq_u32 vcc, 0, v25
    s_nop 0
    s_cbranch_vccnz L_ls_80
L_lb_81:
    v_mfma_f32_16x16x32_bf16 v[124:127], v[112:115], v[92:95], v[124:127]
    ds_read_b32 v184, v56 offset:0
    ds_read_b32 v190, v56 offset:512
    v_mfma_f32_16x16x32_bf16 v[128:131], v[112:115], v[96:99], v[128:131]
    ds_read_b32 v185, v56 offset:64
    ds_read_b32 v191, v56 offset:576
    v_mfma_f32_16x16x32_bf16 v[132:135], v[112:115], v[100:103], v[132:135]
    ds_read_b32 v186, v56 offset:128
    ds_read_b32 v192, v56 offset:640
    v_mfma_f32_16x16x32_bf16 v[136:139], v[112:115], v[104:107], v[136:139]
    ds_read_b32 v187, v56 offset:192
    ds_read_b32 v193, v56 offset:704
    v_mfma_f32_16x16x32_bf16 v[140:143], v[112:115], v[108:111], v[140:143]
    ds_read_b32 v188, v56 offset:256
    ds_read_b32 v194, v56 offset:768
    v_mfma_f32_16x16x32_bf16 v[144:147], v[116:119], v[92:95], v[144:147]
    ds_read_b128 v[196:199], v57 offset:0
    ds_read_b128 v[216:219], v57 offset:512
    v_mfma_f32_16x16x32_bf16 v[148:151], v[116:119], v[96:99], v[148:151]
    ds_read_b128 v[200:203], v57 offset:64
    ds_read_b128 v[220:223], v57 offset:576
    v_mfma_f32_16x16x32_bf16 v[152:155], v[116:119], v[100:103], v[152:155]
    ds_read_b128 v[204:207], v57 offset:128
    ds_read_b128 v[224:227], v57 offset:640
    v_mfma_f32_16x16x32_bf16 v[156:159], v[116:119], v[104:107], v[156:159]
    ds_read_b128 v[208:211], v57 offset:192
    ds_read_b128 v[228:231], v57 offset:704
    v_mfma_f32_16x16x32_bf16 v[160:163], v[116:119], v[108:111], v[160:163]
    ds_read_b128 v[212:215], v57 offset:256
    ds_read_b128 v[232:235], v57 offset:768
    v_mfma_f32_16x16x32_bf16 v[164:167], v[92:95], v[120:123], v[164:167]
    v_mov_b32 v24, 163824
    ds_read_b64 v[4:5], v24
    ds_write_b32 v6, v6 offset:304
    v_mfma_f32_16x16x32_bf16 v[168:171], v[96:99], v[120:123], v[168:171]
    v_mfma_f32_16x16x32_bf16 v[172:175], v[100:103], v[120:123], v[172:175]
    v_mfma_f32_16x16x32_bf16 v[176:179], v[104:107], v[120:123], v[176:179]
    v_mfma_f32_16x16x32_bf16 v[180:183], v[108:111], v[120:123], v[180:183]
    s_waitcnt vmcnt(2)
    v_mov_b32_dpp v36, v124 row_newbcast:0 row_mask:0xf bank_mask:0xf
    v_mov_b32_dpp v37, v125 row_newbcast:0 row_mask:0xf bank_mask:0xf
    v_mov_b32_dpp v38, v126 row_newbcast:0 row_mask:0xf bank_mask:0xf
    v_mov_b32_dpp v39, v127 row_newbcast:0 row_mask:0xf bank_mask:0xf
    v_mov_b32_dpp v56, v144 row_newbcast:0 row_mask:0xf bank_mask:0xf
    v_mov_b32_dpp v57, v145 row_newbcast:0 row_mask:0xf bank_mask:0xf
    v_mov_b32_dpp v58, v146 row_newbcast:0 row_mask:0xf bank_mask:0xf
    v_mov_b32_dpp v59, v147 row_newbcast:0 row_mask:0xf bank_mask:0xf
    s_waitcnt lgkmcnt(15)
    v_pk_fma_f32 v[144:145], v[184:185], v[56:57], v[144:145] op_sel:[0,0,0] op_sel_hi:[0,1,1] neg_lo:[1,0,0] neg_hi:[1,0,0]
    v_pk_fma_f32 v[146:147], v[184:185], v[58:59], v[146:147] op_sel:[0,0,0] op_sel_hi:[0,1,1] neg_lo:[1,0,0] neg_hi:[1,0,0]
    v_pk_mul_f32 v[144:145], v[190:191], v[144:145] op_sel:[0,0] op_sel_hi:[0,1]
    v_pk_mul_f32 v[146:147], v[190:191], v[146:147] op_sel:[0,0] op_sel_hi:[0,1]
    v_mov_b32 v60, v164
    v_mov_b32 v61, v164
    v_cvt_pk_bf16_f32 v70, v144, v145
    v_cvt_pk_bf16_f32 v71, v146, v147
    v_pk_fma_f32 v[128:129], v[184:185], v[36:37], v[128:129] op_sel:[1,0,0] op_sel_hi:[1,1,1] neg_lo:[1,0,0] neg_hi:[1,0,0]
    v_pk_fma_f32 v[130:131], v[184:185], v[38:39], v[130:131] op_sel:[1,0,0] op_sel_hi:[1,1,1] neg_lo:[1,0,0] neg_hi:[1,0,0]
    v_pk_fma_f32 v[148:149], v[184:185], v[56:57], v[148:149] op_sel:[1,0,0] op_sel_hi:[1,1,1] neg_lo:[1,0,0] neg_hi:[1,0,0]
    v_pk_fma_f32 v[150:151], v[184:185], v[58:59], v[150:151] op_sel:[1,0,0] op_sel_hi:[1,1,1] neg_lo:[1,0,0] neg_hi:[1,0,0]
    v_pk_mul_f32 v[148:149], v[190:191], v[148:149] op_sel:[1,0] op_sel_hi:[1,1]
    v_pk_mul_f32 v[150:151], v[190:191], v[150:151] op_sel:[1,0] op_sel_hi:[1,1]
    v_permlane16_swap_b32 v60, v61
    v_cvt_pk_bf16_f32 v62, v128, v129
    v_cvt_pk_bf16_f32 v63, v130, v131
    v_cvt_pk_bf16_f32 v72, v148, v149
    v_cvt_pk_bf16_f32 v73, v150, v151
    v_pk_fma_f32 v[132:133], v[186:187], v[36:37], v[132:133] op_sel:[0,0,0] op_sel_hi:[0,1,1] neg_lo:[1,0,0] neg_hi:[1,0,0]
    v_pk_fma_f32 v[134:135], v[186:187], v[38:39], v[134:135] op_sel:[0,0,0] op_sel_hi:[0,1,1] neg_lo:[1,0,0] neg_hi:[1,0,0]
    v_pk_fma_f32 v[152:153], v[186:187], v[56:57], v[152:153] op_sel:[0,0,0] op_sel_hi:[0,1,1] neg_lo:[1,0,0] neg_hi:[1,0,0]
    v_pk_fma_f32 v[154:155], v[186:187], v[58:59], v[154:155] op_sel:[0,0,0] op_sel_hi:[0,1,1] neg_lo:[1,0,0] neg_hi:[1,0,0]
    s_waitcnt lgkmcnt(14)
    v_pk_mul_f32 v[152:153], v[192:193], v[152:153] op_sel:[0,0] op_sel_hi:[0,1]
    v_pk_mul_f32 v[154:155], v[192:193], v[154:155] op_sel:[0,0] op_sel_hi:[0,1]
    v_mov_b32 v61, v60
    v_cvt_pk_bf16_f32 v64, v132, v133
    v_cvt_pk_bf16_f32 v65, v134, v135
    v_cvt_pk_bf16_f32 v74, v152, v153
    v_cvt_pk_bf16_f32 v75, v154, v155
    v_pk_fma_f32 v[136:137], v[186:187], v[36:37], v[136:137] op_sel:[1,0,0] op_sel_hi:[1,1,1] neg_lo:[1,0,0] neg_hi:[1,0,0]
    v_pk_fma_f32 v[138:139], v[186:187], v[38:39], v[138:139] op_sel:[1,0,0] op_sel_hi:[1,1,1] neg_lo:[1,0,0] neg_hi:[1,0,0]
    v_pk_fma_f32 v[156:157], v[186:187], v[56:57], v[156:157] op_sel:[1,0,0] op_sel_hi:[1,1,1] neg_lo:[1,0,0] neg_hi:[1,0,0]
    v_pk_fma_f32 v[158:159], v[186:187], v[58:59], v[158:159] op_sel:[1,0,0] op_sel_hi:[1,1,1] neg_lo:[1,0,0] neg_hi:[1,0,0]
    v_pk_mul_f32 v[156:157], v[192:193], v[156:157] op_sel:[1,0] op_sel_hi:[1,1]
    v_pk_mul_f32 v[158:159], v[192:193], v[158:159] op_sel:[1,0] op_sel_hi:[1,1]
    v_permlane32_swap_b32 v60, v61
    v_cvt_pk_bf16_f32 v66, v136, v137
    v_cvt_pk_bf16_f32 v67, v138, v139
    v_cvt_pk_bf16_f32 v76, v156, v157
    v_cvt_pk_bf16_f32 v77, v158, v159
    s_waitcnt lgkmcnt(13)
    v_pk_fma_f32 v[140:141], v[188:189], v[36:37], v[140:141] op_sel:[0,0,0] op_sel_hi:[0,1,1] neg_lo:[1,0,0] neg_hi:[1,0,0]
    v_pk_fma_f32 v[142:143], v[188:189], v[38:39], v[142:143] op_sel:[0,0,0] op_sel_hi:[0,1,1] neg_lo:[1,0,0] neg_hi:[1,0,0]
    v_pk_fma_f32 v[160:161], v[188:189], v[56:57], v[160:161] op_sel:[0,0,0] op_sel_hi:[0,1,1] neg_lo:[1,0,0] neg_hi:[1,0,0]
    v_pk_fma_f32 v[162:163], v[188:189], v[58:59], v[162:163] op_sel:[0,0,0] op_sel_hi:[0,1,1] neg_lo:[1,0,0] neg_hi:[1,0,0]
    s_waitcnt lgkmcnt(12)
    v_pk_mul_f32 v[160:161], v[194:195], v[160:161] op_sel:[0,0] op_sel_hi:[0,1]
    v_pk_mul_f32 v[162:163], v[194:195], v[162:163] op_sel:[0,0] op_sel_hi:[0,1]
    v_cvt_pk_bf16_f32 v68, v140, v141
    v_cvt_pk_bf16_f32 v69, v142, v143
    v_cvt_pk_bf16_f32 v78, v160, v161
    v_cvt_pk_bf16_f32 v79, v162, v163
    s_waitcnt lgkmcnt(11)
    v_pk_fma_f32 v[164:165], v[196:197], v[60:61], v[164:165] op_sel_hi:[1,0,1] neg_lo:[1,0,0] neg_hi:[1,0,0]
    v_pk_fma_f32 v[166:167], v[198:199], v[60:61], v[166:167] op_sel_hi:[1,0,1] neg_lo:[1,0,0] neg_hi:[1,0,0]
    s_waitcnt lgkmcnt(10)
    v_pk_mul_f32 v[164:165], v[216:217], v[164:165]
    v_pk_mul_f32 v[166:167], v[218:219], v[166:167]
    s_waitcnt lgkmcnt(9)
    v_pk_fma_f32 v[168:169], v[200:201], v[60:61], v[168:169] op_sel_hi:[1,0,1] neg_lo:[1,0,0] neg_hi:[1,0,0]
    v_pk_fma_f32 v[170:171], v[202:203], v[60:61], v[170:171] op_sel_hi:[1,0,1] neg_lo:[1,0,0] neg_hi:[1,0,0]
    s_waitcnt lgkmcnt(8)
    v_pk_mul_f32 v[168:169], v[220:221], v[168:169]
    v_pk_mul_f32 v[170:171], v[222:223], v[170:171]
    s_waitcnt lgkmcnt(7)
    v_pk_fma_f32 v[172:173], v[204:205], v[60:61], v[172:173] op_sel_hi:[1,0,1] neg_lo:[1,0,0] neg_hi:[1,0,0]
    v_pk_fma_f32 v[174:175], v[206:207], v[60:61], v[174:175] op_sel_hi:[1,0,1] neg_lo:[1,0,0] neg_hi:[1,0,0]
    s_waitcnt lgkmcnt(6)
    v_pk_mul_f32 v[172:173], v[224:225], v[172:173]
    v_pk_mul_f32 v[174:175], v[226:227], v[174:175]
    s_waitcnt lgkmcnt(5)
    v_pk_fma_f32 v[176:177], v[208:209], v[60:61], v[176:177] op_sel_hi:[1,0,1] neg_lo:[1,0,0] neg_hi:[1,0,0]
    v_pk_fma_f32 v[178:179], v[210:211], v[60:61], v[178:179] op_sel_hi:[1,0,1] neg_lo:[1,0,0] neg_hi:[1,0,0]
    s_waitcnt lgkmcnt(4)
    v_pk_mul_f32 v[176:177], v[228:229], v[176:177]
    v_pk_mul_f32 v[178:179], v[230:231], v[178:179]
    s_waitcnt lgkmcnt(3)
    v_pk_fma_f32 v[180:181], v[212:213], v[60:61], v[180:181] op_sel_hi:[1,0,1] neg_lo:[1,0,0] neg_hi:[1,0,0]
    v_pk_fma_f32 v[182:183], v[214:215], v[60:61], v[182:183] op_sel_hi:[1,0,1] neg_lo:[1,0,0] neg_hi:[1,0,0]
    s_waitcnt lgkmcnt(2)
    v_pk_mul_f32 v[180:181], v[232:233], v[180:181]
    v_pk_mul_f32 v[182:183], v[234:235], v[182:183]
    v_mfma_f32_16x16x16_bf16 v[128:131], v[70:71], v[62:63], v[48:51]
    v_cvt_pk_bf16_f32 v80, v164, v165
    v_cvt_pk_bf16_f32 v81, v166, v167
    v_mfma_f32_16x16x16_bf16 v[148:151], v[72:73], v[62:63], v[40:43]
    v_cvt_pk_bf16_f32 v82, v168, v169
    v_cvt_pk_bf16_f32 v83, v170, v171
    v_mfma_f32_16x16x16_bf16 v[132:135], v[72:73], v[64:65], v[44:47]
    v_cvt_pk_bf16_f32 v84, v172, v173
    v_cvt_pk_bf16_f32 v85, v174, v175
    v_mfma_f32_16x16x16_bf16 v[152:155], v[74:75], v[64:65], v[40:43]
    v_cvt_pk_bf16_f32 v86, v176, v177
    v_cvt_pk_bf16_f32 v87, v178, v179
    v_mfma_f32_16x16x16_bf16 v[136:139], v[74:75], v[66:67], v[44:47]
    v_cvt_pk_bf16_f32 v88, v180, v181
    v_cvt_pk_bf16_f32 v89, v182, v183
    v_mfma_f32_16x16x16_bf16 v[156:159], v[76:77], v[66:67], v[40:43]
    v_mul_f32 v90, s61, v191
    v_mul_f32 v91, s61, v192
    v_mfma_f32_16x16x16_bf16 v[140:143], v[76:77], v[68:69], v[44:47]
    v_mul_f32 v92, s61, v193
    v_mul_f32 v93, s61, v194
    v_mfma_f32_16x16x16_bf16 v[160:163], v[78:79], v[68:69], v[40:43]
    s_waitcnt lgkmcnt(1)
    v_readfirstlane_b32 s70, v4
    v_readfirstlane_b32 s71, v5
    v_max3_f32 v94, v128, v129, v148
    v_max3_f32 v95, v130, v131, v150
    v_max3_f32 v96, v132, v133, v152
    v_max3_f32 v97, v134, v135, v154
    v_max3_f32 v98, v136, v137, v156
    v_max3_f32 v99, v138, v139, v158
    v_max3_f32 v100, v140, v141, v160
    v_max3_f32 v101, v142, v143, v162
    v_max_f32 v94, v94, v149
    v_max_f32 v95, v95, v151
    v_max_f32 v96, v96, v153
    v_max_f32 v97, v97, v155
    v_max_f32 v98, v98, v157
    v_max_f32 v99, v99, v159
    v_max_f32 v100, v100, v161
    v_max_f32 v101, v101, v163
    v_max_f32 v102, v94, v95
    v_max_f32 v103, v96, v97
    v_max_f32 v104, v98, v99
    v_max_f32 v105, v100, v101
    v_max_f32 v106, v94, v95
    v_max_f32 v107, v96, v97
    v_max_f32 v108, v98, v99
    v_max_f32 v109, v100, v101
    v_permlane16_swap_b32 v102, v106
    v_permlane16_swap_b32 v103, v107
    v_permlane16_swap_b32 v104, v108
    v_permlane16_swap_b32 v105, v109
    v_max_f32 v102, v102, v106
    v_max_f32 v103, v103, v107
    v_max_f32 v104, v104, v108
    v_max_f32 v105, v105, v109
    v_mov_b32 v106, v102
    v_mov_b32 v107, v103
    v_mov_b32 v108, v104
    v_mov_b32 v109, v105
    v_permlane32_swap_b32 v102, v106
    v_permlane32_swap_b32 v103, v107
    v_permlane32_swap_b32 v104, v108
    v_permlane32_swap_b32 v105, v109
    v_max_f32 v102, v102, v106
    v_max_f32 v103, v103, v107
    v_max_f32 v104, v104, v108
    v_max_f32 v105, v105, v109
    v_sub_f32 v94, v94, v102
    v_sub_f32 v95, v95, v102
    v_sub_f32 v96, v96, v103
    v_sub_f32 v97, v97, v103
    v_sub_f32 v98, v98, v104
    v_sub_f32 v99, v99, v104
    v_sub_f32 v100, v100, v105
    v_sub_f32 v101, v101, v105
    v_mul_f32 v94, v94, v90
    v_mul_f32 v95, v95, v90
    v_mul_f32 v96, v96, v91
    v_mul_f32 v97, v97, v91
    v_mul_f32 v98, v98, v92
    v_mul_f32 v99, v99, v92
    v_mul_f32 v100, v100, v93
    v_mul_f32 v101, v101, v93
    v_exp_f32 v94, v94
    v_exp_f32 v95, v95
    v_exp_f32 v96, v96
    v_exp_f32 v97, v97
    v_exp_f32 v98, v98
    v_exp_f32 v99, v99
    v_exp_f32 v100, v100
    v_exp_f32 v101, v101
    v_cvt_pk_bf16_f32 v94, v94, v94
    v_cvt_pk_bf16_f32 v95, v95, v95
    v_cvt_pk_bf16_f32 v96, v96, v96
    v_cvt_pk_bf16_f32 v97, v97, v97
    v_cvt_pk_bf16_f32 v98, v98, v98
    v_cvt_pk_bf16_f32 v99, v99, v99
    v_cvt_pk_bf16_f32 v100, v100, v100
    v_cvt_pk_bf16_f32 v101, v101, v101
    v_and_b32 v112, v52, v94
    v_and_b32 v113, v53, v95
    v_and_b32 v114, v54, v94
    v_and_b32 v115, v55, v95
    v_and_b32 v116, v52, v96
    v_and_b32 v117, v53, v97
    v_and_b32 v118, v54, v96
    v_and_b32 v119, v55, v97
    v_mfma_f32_16x16x32_bf16 v[128:131], v[28:31], v[112:115], 0
    v_mfma_f32_16x16x32_bf16 v[148:151], v[80:83], v[112:115], 0
    v_and_b32 v120, v52, v98
    v_and_b32 v121, v53, v99
    v_and_b32 v122, v54, v98
    v_and_b32 v123, v55, v99
    v_mfma_f32_16x16x32_bf16 v[132:135], v[28:31], v[116:119], 0
    v_mfma_f32_16x16x32_bf16 v[152:155], v[82:85], v[116:119], 0
    v_and_b32 v236, v52, v100
    v_and_b32 v237, v53, v101
    v_and_b32 v238, v54, v100
    v_and_b32 v239, v55, v101
    v_mfma_f32_16x16x32_bf16 v[136:139], v[28:31], v[120:123], 0
    v_mfma_f32_16x16x32_bf16 v[156:159], v[84:87], v[120:123], 0
    v_mfma_f32_16x16x32_bf16 v[140:143], v[28:31], v[236:239], 0
    v_mfma_f32_16x16x32_bf16 v[160:163], v[86:89], v[236:239], 0
    s_waitcnt vmcnt(0)
    v_rcp_f32 v102, v128
    v_rcp_f32 v103, v132
    v_mul_f32 v148, v102, v148
    v_mul_f32 v149, v102, v149
    v_mul_f32 v150, v102, v150
    v_mul_f32 v151, v102, v151
    v_mul_f32 v152, v103, v152
    v_mul_f32 v153, v103, v153
    v_mul_f32 v154, v103, v154
    v_mul_f32 v155, v103, v155
    v_cvt_pk_bf16_f32 v112, v148, v149
    v_cvt_pk_bf16_f32 v113, v150, v151
    v_cvt_pk_bf16_f32 v114, v152, v153
    v_cvt_pk_bf16_f32 v115, v154, v155
    s_nop 0
    v_permlane16_swap_b32 v112, v114
    v_permlane16_swap_b32 v113, v115
    buffer_store_dwordx4 v[112:115], v2, s[40:43], s74 offen sc1
    v_rcp_f32 v104, v136
    v_rcp_f32 v105, v140
    v_mul_f32 v156, v104, v156
    v_mul_f32 v157, v104, v157
    v_mul_f32 v158, v104, v158
    v_mul_f32 v159, v104, v159
    v_mul_f32 v160, v105, v160
    v_mul_f32 v161, v105, v161
    v_mul_f32 v162, v105, v162
    v_mul_f32 v163, v105, v163
    v_cvt_pk_bf16_f32 v120, v156, v157
    v_cvt_pk_bf16_f32 v121, v158, v159
    v_cvt_pk_bf16_f32 v122, v160, v161
    v_cvt_pk_bf16_f32 v123, v162, v163
    s_nop 0
    v_permlane16_swap_b32 v120, v122
    v_permlane16_swap_b32 v121, v123
    buffer_store_dwordx4 v[120:123], v2, s[40:43], s75 offen sc1
    s_xor_b32 s5, s44, 1
    s_lshl_b32 s5, s5, 14
    s_add_u32 s5, s5, 65536
    v_add_u32 v24, s5, v2
    s_xor_b32 s5, s44, 2
    s_lshl_b32 s5, s5, 14
    s_add_u32 s5, s5, 69632
    v_add_u32 v25, s5, v2
    s_xor_b32 s5, s44, 3
    s_lshl_b32 s5, s5, 14
    s_add_u32 s5, s5, 73728
    v_add_u32 v26, s5, v2
    s_lshl_b32 s5, s44, 14
    s_add_u32 s5, s5, 65536
    v_add_u32 v228, s5, v2
    v_add_u32 v0, s5, v32
    v_xor_b32 v20, 64, v0
    ds_read_b32 v21, v7 offset:0
    v_lshlrev_b32 v164, 16, v12
    v_and_b32 v165, 0xffff0000, v12
    v_lshlrev_b32 v166, 16, v13
    v_and_b32 v167, 0xffff0000, v13
    v_lshlrev_b32 v168, 16, v14
    v_and_b32 v169, 0xffff0000, v14
    v_lshlrev_b32 v170, 16, v15
    v_and_b32 v171, 0xffff0000, v15
    v_lshlrev_b32 v172, 16, v16
    v_and_b32 v173, 0xffff0000, v16
    v_lshlrev_b32 v174, 16, v17
    v_and_b32 v175, 0xffff0000, v17
    v_lshlrev_b32 v176, 16, v18
    v_and_b32 v177, 0xffff0000, v18
    v_lshlrev_b32 v178, 16, v19
    v_and_b32 v179, 0xffff0000, v19
    s_waitcnt vmcnt(0)
    s_mov_b64 exec, 1
    buffer_store_dwordx2 v[4:5], v10, s[40:43], s76 offen offset:0
    s_mov_b64 exec, -1
    s_waitcnt lgkmcnt(0)
    v_cmp_eq_u32 vcc, 0, v21
    s_nop 0
    s_cbranch_vccnz L_ls_83
L_lb_84:
    ds_read_b64_tr_b16 v[36:37], v0 offset:0
    ds_read_b64_tr_b16 v[38:39], v0 offset:512
    ds_read_b64_tr_b16 v[40:41], v20 offset:0
    ds_read_b64_tr_b16 v[42:43], v20 offset:512
    ds_read_b64_tr_b16 v[44:45], v0 offset:2048
    ds_read_b64_tr_b16 v[46:47], v0 offset:2560
    ds_read_b64_tr_b16 v[48:49], v20 offset:2048
    ds_read_b64_tr_b16 v[50:51], v20 offset:2560
    ds_read_b64_tr_b16 v[52:53], v0 offset:4096
    ds_read_b64_tr_b16 v[54:55], v0 offset:4608
    ds_read_b64_tr_b16 v[56:57], v20 offset:4096
    ds_read_b64_tr_b16 v[58:59], v20 offset:4608
    ds_read_b64_tr_b16 v[60:61], v0 offset:6144
    ds_read_b64_tr_b16 v[62:63], v0 offset:6656
    ds_read_b64_tr_b16 v[64:65], v20 offset:6144
    ds_read_b64_tr_b16 v[66:67], v20 offset:6656
    ds_read_b64_tr_b16 v[68:69], v0 offset:8192
    ds_read_b64_tr_b16 v[70:71], v0 offset:8704
    ds_read_b64_tr_b16 v[72:73], v20 offset:8192
    ds_read_b64_tr_b16 v[74:75], v20 offset:8704
    ds_read_b64_tr_b16 v[76:77], v0 offset:10240
    ds_read_b64_tr_b16 v[78:79], v0 offset:10752
    ds_read_b64_tr_b16 v[80:81], v20 offset:10240
    ds_read_b64_tr_b16 v[82:83], v20 offset:10752
    ds_read_b64_tr_b16 v[84:85], v0 offset:12288
    ds_read_b64_tr_b16 v[86:87], v0 offset:12800
    ds_read_b64_tr_b16 v[88:89], v20 offset:12288
    ds_read_b64_tr_b16 v[90:91], v20 offset:12800
    ds_read_b64_tr_b16 v[92:93], v0 offset:14336
    ds_read_b64_tr_b16 v[94:95], v0 offset:14848
    ds_read_b64_tr_b16 v[96:97], v20 offset:14336
    ds_read_b64_tr_b16 v[98:99], v20 offset:14848
    ds_write_b32 v6, v6 offset:16
    s_mov_b32 s52, 0
    s_nop 0
L_poll_86:
    buffer_load_dwordx2 v[22:23], v33, s[40:43], 0 offen offset:0 sc1
    s_add_u32 s52, s52, 1
    s_cmp_gt_u32 s52, 24
    s_cbranch_scc1 L_slow_88
    s_waitcnt vmcnt(0)
    v_cmp_ne_u64 vcc, s[70:71], v[22:23]
    s_nop 0
    s_cbranch_vccnz L_poll_86
    s_nop 2
L_go_87:
    buffer_load_dwordx4 v[104:107], v2, s[40:43], s79 offen offset:0 sc1
    buffer_load_dwordx4 v[112:115], v2, s[40:43], s79 offen offset:1024 sc1
    buffer_load_dwordx4 v[120:123], v2, s[40:43], s79 offen offset:2048 sc1
    buffer_load_dwordx4 v[128:131], v2, s[40:43], s79 offen offset:3072 sc1
    buffer_load_dwordx4 v[136:139], v2, s[40:43], s80 offen offset:0 sc1
    buffer_load_dwordx4 v[144:147], v2, s[40:43], s80 offen offset:1024 sc1
    buffer_load_dwordx4 v[152:155], v2, s[40:43], s80 offen offset:2048 sc1
    buffer_load_dwordx4 v[160:163], v2, s[40:43], s80 offen offset:3072 sc1
    s_waitcnt vmcnt(7) lgkmcnt(15)
    v_mfma_f32_32x32x16_bf16 v[212:227], v[40:43], v[104:107], 0
    buffer_load_dwordx4 v[100:103], v2, s[40:43], s77 offen offset:0 sc1
    v_mfma_f32_32x32x16_bf16 v[196:211], v[36:39], v[104:107], 0
    s_waitcnt vmcnt(7)
    v_mfma_f32_32x32x16_bf16 v[212:227], v[48:51], v[112:115], v[212:227]
    buffer_load_dwordx4 v[108:111], v2, s[40:43], s77 offen offset:1024 sc1
    v_mfma_f32_32x32x16_bf16 v[196:211], v[44:47], v[112:115], v[196:211]
    s_waitcnt vmcnt(7)
    v_mfma_f32_32x32x16_bf16 v[212:227], v[56:59], v[120:123], v[212:227]
    buffer_load_dwordx4 v[116:119], v2, s[40:43], s77 offen offset:2048 sc1
    v_mfma_f32_32x32x16_bf16 v[196:211], v[52:55], v[120:123], v[196:211]
    s_waitcnt vmcnt(7)
    v_mfma_f32_32x32x16_bf16 v[212:227], v[64:67], v[128:131], v[212:227]
    buffer_load_dwordx4 v[124:127], v2, s[40:43], s77 offen offset:3072 sc1
    v_mfma_f32_32x32x16_bf16 v[196:211], v[60:63], v[128:131], v[196:211]
    s_waitcnt vmcnt(7) lgkmcnt(13)
    v_mfma_f32_32x32x16_bf16 v[212:227], v[72:75], v[136:139], v[212:227]
    buffer_load_dwordx4 v[132:135], v2, s[40:43], s78 offen offset:0 sc1
    v_mfma_f32_32x32x16_bf16 v[196:211], v[68:71], v[136:139], v[196:211]
    s_waitcnt vmcnt(7) lgkmcnt(9)
    v_mfma_f32_32x32x16_bf16 v[212:227], v[80:83], v[144:147], v[212:227]
    buffer_load_dwordx4 v[140:143], v2, s[40:43], s78 offen offset:1024 sc1
    v_mfma_f32_32x32x16_bf16 v[196:211], v[76:79], v[144:147], v[196:211]
    s_waitcnt vmcnt(7) lgkmcnt(5)
    v_mfma_f32_32x32x16_bf16 v[212:227], v[88:91], v[152:155], v[212:227]
    buffer_load_dwordx4 v[148:151], v2, s[40:43], s78 offen offset:2048 sc1
    ds_read_b32 v21, v8 offset:16
    v_mfma_f32_32x32x16_bf16 v[196:211], v[84:87], v[152:155], v[196:211]
    s_waitcnt vmcnt(7) lgkmcnt(2)
    v_mfma_f32_32x32x16_bf16 v[212:227], v[96:99], v[160:163], v[212:227]
    buffer_load_dwordx4 v[156:159], v2, s[40:43], s78 offen offset:3072 sc1
    ds_write_b32 v6, v6 offset:560
    v_mfma_f32_32x32x16_bf16 v[196:211], v[92:95], v[160:163], v[196:211]
    s_waitcnt vmcnt(7)
    v_mfma_f32_32x32x16_bf16 v[180:195], v[40:43], v[100:103], 0
    s_lshl_b32 s4, s76, 4
    s_add_u32 s4, s4, 4125097984
    s_mov_b64 exec, 0xffff
    buffer_store_dwordx2 v[4:5], v9, s[40:43], s4 offen sc1
    s_mov_b64 exec, -1
    v_mfma_f32_32x32x16_bf16 v[164:179], v[36:39], v[100:103], v[164:179]
    s_waitcnt lgkmcnt(1)
    v_cmp_eq_u32 vcc, 0, v21
    s_nop 0
    s_cbranch_vccnz L_ls_90
L_lb_91:
    s_waitcnt vmcnt(7)
    v_mfma_f32_32x32x16_bf16 v[180:195], v[48:51], v[108:111], v[180:195]
    v_mfma_f32_32x32x16_bf16 v[164:179], v[44:47], v[108:111], v[164:179]
    ds_write_b128 v26, v[212:215] offset:0
    s_waitcnt vmcnt(6)
    v_mfma_f32_32x32x16_bf16 v[180:195], v[56:59], v[116:119], v[180:195]
    ds_write_b128 v26, v[216:219] offset:1024
    v_mfma_f32_32x32x16_bf16 v[164:179], v[52:55], v[116:119], v[164:179]
    s_waitcnt vmcnt(5)
    v_mfma_f32_32x32x16_bf16 v[180:195], v[64:67], v[124:127], v[180:195]
    ds_write_b128 v26, v[220:223] offset:2048
    v_mfma_f32_32x32x16_bf16 v[164:179], v[60:63], v[124:127], v[164:179]
    ds_write_b128 v26, v[224:227] offset:3072
    s_waitcnt vmcnt(4)
    v_mfma_f32_32x32x16_bf16 v[180:195], v[72:75], v[132:135], v[180:195]
    v_mfma_f32_32x32x16_bf16 v[164:179], v[68:71], v[132:135], v[164:179]
    ds_write_b128 v25, v[196:199] offset:0
    s_waitcnt vmcnt(3)
    v_mfma_f32_32x32x16_bf16 v[180:195], v[80:83], v[140:143], v[180:195]
    ds_write_b128 v25, v[200:203] offset:1024
    v_mfma_f32_32x32x16_bf16 v[164:179], v[76:79], v[140:143], v[164:179]
    s_waitcnt vmcnt(2)
    v_mfma_f32_32x32x16_bf16 v[180:195], v[88:91], v[148:151], v[180:195]
    ds_write_b128 v25, v[204:207] offset:2048
    v_mfma_f32_32x32x16_bf16 v[164:179], v[84:87], v[148:151], v[164:179]
    ds_write_b128 v25, v[208:211] offset:3072
    s_waitcnt vmcnt(1)
    v_mfma_f32_32x32x16_bf16 v[180:195], v[96:99], v[156:159], v[180:195]
    v_mfma_f32_32x32x16_bf16 v[164:179], v[92:95], v[156:159], v[164:179]
    s_nop 10
    ds_write_b128 v24, v[180:183] offset:0
    ds_write_b128 v24, v[184:187] offset:1024
    ds_write_b128 v24, v[188:191] offset:2048
    ds_write_b128 v24, v[192:195] offset:3072
    ds_write_b32 v6, v6 offset:32
    s_mov_b32 s53, 0
    s_nop 0
L_lw_93:
    ds_read_b32 v21, v8 offset:32
    s_add_u32 s53, s53, 1
    s_cmp_gt_u32 s53, 1048576
    s_cbranch_scc1 L_lg_94
    s_waitcnt lgkmcnt(0)
    v_cmp_eq_u32 vcc, 0, v21
    s_nop 0
    s_cbranch_vccnz L_lw_93
    s_nop 2
L_lg_94:
    ds_read_b128 v[36:39], v228 offset:0
    ds_read_b128 v[40:43], v228 offset:1024
    ds_read_b128 v[44:47], v228 offset:2048
    ds_read_b128 v[48:51], v228 offset:3072
    ds_read_b128 v[52:55], v228 offset:4096
    ds_read_b128 v[56:59], v228 offset:5120
    ds_read_b128 v[60:63], v228 offset:6144
    ds_read_b128 v[64:67], v228 offset:7168
    ds_read_b128 v[68:71], v228 offset:8192
    ds_read_b128 v[72:75], v228 offset:9216
    ds_read_b128 v[76:79], v228 offset:10240
    ds_read_b128 v[80:83], v228 offset:11264
    ds_write_b32 v6, v6 offset:48
    s_waitcnt lgkmcnt(12)
    v_pk_add_f32 v[164:165], v[164:165], v[36:37]
    v_pk_add_f32 v[166:167], v[166:167], v[38:39]
    s_waitcnt lgkmcnt(11)
    v_pk_add_f32 v[168:169], v[168:169], v[40:41]
    v_pk_add_f32 v[170:171], v[170:171], v[42:43]
    s_waitcnt lgkmcnt(10)
    v_pk_add_f32 v[172:173], v[172:173], v[44:45]
    v_pk_add_f32 v[174:175], v[174:175], v[46:47]
    s_waitcnt lgkmcnt(9)
    v_pk_add_f32 v[176:177], v[176:177], v[48:49]
    v_pk_add_f32 v[178:179], v[178:179], v[50:51]
    s_waitcnt lgkmcnt(8)
    v_pk_add_f32 v[164:165], v[164:165], v[52:53]
    v_pk_add_f32 v[166:167], v[166:167], v[54:55]
    s_waitcnt lgkmcnt(7)
    v_pk_add_f32 v[168:169], v[168:169], v[56:57]
    v_pk_add_f32 v[170:171], v[170:171], v[58:59]
    s_waitcnt lgkmcnt(6)
    v_pk_add_f32 v[172:173], v[172:173], v[60:61]
    v_pk_add_f32 v[174:175], v[174:175], v[62:63]
    s_waitcnt lgkmcnt(5)
    v_pk_add_f32 v[176:177], v[176:177], v[64:65]
    v_pk_add_f32 v[178:179], v[178:179], v[66:67]
    s_waitcnt lgkmcnt(4)
    v_pk_add_f32 v[164:165], v[164:165], v[68:69]
    v_pk_add_f32 v[166:167], v[166:167], v[70:71]
    s_waitcnt lgkmcnt(3)
    v_pk_add_f32 v[168:169], v[168:169], v[72:73]
    v_pk_add_f32 v[170:171], v[170:171], v[74:75]
    s_waitcnt lgkmcnt(2)
    v_pk_add_f32 v[172:173], v[172:173], v[76:77]
    v_pk_add_f32 v[174:175], v[174:175], v[78:79]
    s_waitcnt lgkmcnt(1)
    v_pk_add_f32 v[176:177], v[176:177], v[80:81]
    v_pk_add_f32 v[178:179], v[178:179], v[82:83]
    v_cvt_pk_bf16_f32 v12, v164, v165
    v_cvt_pk_bf16_f32 v13, v166, v167
    v_cvt_pk_bf16_f32 v14, v168, v169
    v_cvt_pk_bf16_f32 v15, v170, v171
    v_cvt_pk_bf16_f32 v16, v172, v173
    v_cvt_pk_bf16_f32 v17, v174, v175
    v_cvt_pk_bf16_f32 v18, v176, v177
    v_cvt_pk_bf16_f32 v19, v178, v179
    buffer_store_dwordx4 v[12:15], v2, s[40:43], s83 offen sc1
    buffer_store_dwordx4 v[16:19], v2, s[40:43], s83 offen offset:1024 sc1
    v_pk_add_f32 v[180:181], v[164:165], v[166:167]
    v_pk_mul_f32 v[182:183], v[164:165], v[164:165]
    v_pk_fma_f32 v[182:183], v[166:167], v[166:167], v[182:183]
    v_pk_add_f32 v[180:181], v[180:181], v[168:169]
    v_pk_fma_f32 v[182:183], v[168:169], v[168:169], v[182:183]
    v_pk_add_f32 v[180:181], v[180:181], v[170:171]
    v_pk_fma_f32 v[182:183], v[170:171], v[170:171], v[182:183]
    v_pk_add_f32 v[180:181], v[180:181], v[172:173]
    v_pk_fma_f32 v[182:183], v[172:173], v[172:173], v[182:183]
    v_pk_add_f32 v[180:181], v[180:181], v[174:175]
    v_pk_fma_f32 v[182:183], v[174:175], v[174:175], v[182:183]
    v_pk_add_f32 v[180:181], v[180:181], v[176:177]
    v_pk_fma_f32 v[182:183], v[176:177], v[176:177], v[182:183]
    v_pk_add_f32 v[180:181], v[180:181], v[178:179]
    v_pk_fma_f32 v[182:183], v[178:179], v[178:179], v[182:183]
    v_add_f32 v180, v180, v181
    v_add_f32 v182, v182, v183
    s_nop 1
    v_permlane32_swap_b32 v180, v182
    v_add_f32 v180, v180, v182
    buffer_store_dword v180, v11, s[40:43], s84 offen sc1
    v_add_u32 v33, 0x10000, v2
    v_add_u32 v254, 155648, v2
    s_add_u32 s54, s88, 4096
    s_waitcnt vmcnt(0)
    s_mov_b64 exec, 1
    buffer_store_dwordx2 v[4:5], v10, s[40:43], s85 offen offset:0
    s_mov_b64 exec, -1
    s_cmp_eq_u32 s68, 15
    s_nop 0
    s_cbranch_scc1 L_skipC
    v_or_b32 v240, 64, v34
    s_mov_b32 s52, 0
    s_nop 0
L_poll_103:
    buffer_load_dwordx2 v[24:25], v240, s[40:43], 0 offen offset:0 sc1
    s_add_u32 s52, s52, 1
    s_cmp_gt_u32 s52, 24
    s_cbranch_scc1 L_slow_105
    s_waitcnt vmcnt(0)
    v_cmp_ne_u64 vcc, s[70:71], v[24:25]
    s_nop 0
    s_cbranch_vccnz L_poll_103
    s_nop 2
L_go_104:
    ds_read_b32 v26, v8 offset:64
    s_add_u32 s55, s86, 16384
    buffer_load_dwordx4 v[36:39], v2, s[40:43], s55 offen offset:0 sc1
    buffer_load_dwordx4 v[40:43], v2, s[40:43], s55 offen offset:1024 sc1
    buffer_load_dwordx4 v[44:47], v2, s[40:43], s55 offen offset:2048 sc1
    buffer_load_dwordx4 v[48:51], v2, s[40:43], s55 offen offset:3072 sc1
    s_add_u32 s55, s86, 20480
    buffer_load_dwordx4 v[52:55], v2, s[40:43], s55 offen offset:0 sc1
    buffer_load_dwordx4 v[56:59], v2, s[40:43], s55 offen offset:1024 sc1
    buffer_load_dwordx4 v[60:63], v2, s[40:43], s55 offen offset:2048 sc1
    buffer_load_dwordx4 v[64:67], v2, s[40:43], s55 offen offset:3072 sc1
    s_waitcnt lgkmcnt(0)
    v_cmp_eq_u32 vcc, 0, v26
    s_nop 0
    s_cbranch_vccnz L_ls_107
L_lb_108:
    ds_read_b128 v[20:23], v2 offset:16384
    ds_read_b128 v[28:31], v2 offset:49152
    ds_read_b128 v[228:231], v2 offset:17408
    ds_read_b128 v[232:235], v2 offset:50176
    s_waitcnt lgkmcnt(2)
    s_waitcnt vmcnt(7)
    v_mfma_f32_32x32x16_bf16 v[164:179], v[20:23], v[36:39], 0
    ds_read_b128 v[236:239], v2 offset:18432
    s_add_u32 s55, s86, 24576
    buffer_load_dwordx4 v[68:71], v2, s[40:43], s55 offen offset:0 sc1
    ds_write_b32 v6, v6 offset:576
    v_mfma_f32_32x32x16_bf16 v[180:195], v[28:31], v[36:39], 0
    ds_read_b128 v[20:23], v2 offset:51200
    s_waitcnt lgkmcnt(3)
    s_waitcnt vmcnt(7)
    v_mfma_f32_32x32x16_bf16 v[164:179], v[228:231], v[40:43], v[164:179]
    ds_read_b128 v[28:31], v2 offset:19456
    buffer_load_dwordx4 v[72:75], v2, s[40:43], s55 offen offset:1024 sc1
    v_mfma_f32_32x32x16_bf16 v[180:195], v[232:235], v[40:43], v[180:195]
    ds_read_b32 v26, v8 offset:80
    ds_read_b128 v[228:231], v2 offset:52224
    s_waitcnt lgkmcnt(3)
    s_waitcnt vmcnt(7)
    v_mfma_f32_32x32x16_bf16 v[164:179], v[236:239], v[44:47], v[164:179]
    ds_read_b128 v[232:235], v2 offset:20480
    buffer_load_dwordx2 v[24:25], v34, s[40:43], 0 offen offset:0 sc1
    buffer_load_dwordx4 v[76:79], v2, s[40:43], s55 offen offset:2048 sc1
    v_mfma_f32_32x32x16_bf16 v[180:195], v[20:23], v[44:47], v[180:195]
    ds_read_b128 v[236:239], v2 offset:53248
    s_waitcnt lgkmcnt(2)
    s_waitcnt vmcnt(8)
    v_mfma_f32_32x32x16_bf16 v[164:179], v[28:31], v[48:51], v[164:179]
    ds_read_b128 v[20:23], v2 offset:21504
    buffer_load_dwordx4 v[80:83], v2, s[40:43], s55 offen offset:3072 sc1
    v_mfma_f32_32x32x16_bf16 v[180:195], v[228:231], v[48:51], v[180:195]
    v_cmp_eq_u32 vcc, 0, v26
    s_nop 0
    s_cbranch_vccnz L_ls_110
L_lb_111:
    ds_read_b128 v[28:31], v2 offset:54272
    s_waitcnt lgkmcnt(2)
    s_waitcnt vmcnt(8)
    v_mfma_f32_32x32x16_bf16 v[164:179], v[232:235], v[52:55], v[164:179]
    ds_read_b128 v[228:231], v33 offset:16384
    s_add_u32 s55, s86, 28672
    buffer_load_dwordx4 v[84:87], v2, s[40:43], s55 offen offset:0 sc1
    v_mfma_f32_32x32x16_bf16 v[180:195], v[236:239], v[52:55], v[180:195]
    ds_read_b128 v[232:235], v33 offset:49152
    s_waitcnt lgkmcnt(2)
    s_waitcnt vmcnt(8)
    v_mfma_f32_32x32x16_bf16 v[164:179], v[20:23], v[56:59], v[164:179]
    ds_read_b128 v[236:239], v2 offset:22528
    buffer_load_dwordx4 v[88:91], v2, s[40:43], s55 offen offset:1024 sc1
    v_mfma_f32_32x32x16_bf16 v[180:195], v[28:31], v[56:59], v[180:195]
    ds_read_b128 v[20:23], v2 offset:55296
    s_waitcnt lgkmcnt(2)
    v_mfma_f32_32x32x16_bf16 v[196:211], v[228:231], v[36:39], 0
    ds_read_b128 v[28:31], v2 offset:23552
    buffer_load_dwordx4 v[92:95], v2, s[40:43], s55 offen offset:2048 sc1
    v_mfma_f32_32x32x16_bf16 v[212:227], v[232:235], v[36:39], 0
    ds_read_b128 v[228:231], v2 offset:56320
    s_waitcnt lgkmcnt(2)
    s_waitcnt vmcnt(9)
    v_mfma_f32_32x32x16_bf16 v[164:179], v[236:239], v[60:63], v[164:179]
    ds_read_b128 v[232:235], v33 offset:17408
    buffer_load_dwordx4 v[96:99], v2, s[40:43], s55 offen offset:3072 sc1
    v_mfma_f32_32x32x16_bf16 v[180:195], v[20:23], v[60:63], v[180:195]
    ds_read_b128 v[236:239], v33 offset:50176
    s_waitcnt lgkmcnt(2)
    s_waitcnt vmcnt(9)
    v_mfma_f32_32x32x16_bf16 v[164:179], v[28:31], v[64:67], v[164:179]
    ds_read_b128 v[20:23], v2 offset:24576
    s_waitcnt vmcnt(6)
    v_cmp_ne_u64 vcc, s[70:71], v[24:25]
    s_nop 0
    s_cbranch_vccnz L_as_128
L_ab_129:
    buffer_load_dword v148, v11, s[40:43], s87 offen offset:0 sc1
    buffer_load_dword v149, v11, s[40:43], s87 offen offset:256 sc1
    v_mfma_f32_32x32x16_bf16 v[180:195], v[228:231], v[64:67], v[180:195]
    ds_read_b128 v[28:31], v2 offset:57344
    buffer_load_dword v150, v11, s[40:43], s87 offen offset:512 sc1
    buffer_load_dword v151, v11, s[40:43], s87 offen offset:768 sc1
    s_waitcnt lgkmcnt(2)
    v_mfma_f32_32x32x16_bf16 v[196:211], v[232:235], v[40:43], v[196:211]
    ds_read_b128 v[228:231], v2 offset:25600
    buffer_load_dword v152, v11, s[40:43], s87 offen offset:1024 sc1
    buffer_load_dword v153, v11, s[40:43], s87 offen offset:1280 sc1
    v_mfma_f32_32x32x16_bf16 v[212:227], v[236:239], v[40:43], v[212:227]
    ds_read_b128 v[232:235], v2 offset:58368
    buffer_load_dword v154, v11, s[40:43], s87 offen offset:1536 sc1
    buffer_load_dword v155, v11, s[40:43], s87 offen offset:1792 sc1
    s_waitcnt lgkmcnt(2)
    v_mfma_f32_32x32x16_bf16 v[164:179], v[20:23], v[68:71], v[164:179]
    ds_read_b128 v[236:239], v33 offset:18432
    buffer_load_dword v156, v11, s[40:43], s87 offen offset:2048 sc1
    buffer_load_dword v157, v11, s[40:43], s87 offen offset:2304 sc1
    v_mfma_f32_32x32x16_bf16 v[180:195], v[28:31], v[68:71], v[180:195]
    ds_read_b128 v[20:23], v33 offset:51200
    buffer_load_dword v158, v11, s[40:43], s87 offen offset:2560 sc1
    buffer_load_dword v159, v11, s[40:43], s87 offen offset:2816 sc1
    s_waitcnt lgkmcnt(2)
    v_mfma_f32_32x32x16_bf16 v[164:179], v[228:231], v[72:75], v[164:179]
    ds_read_b128 v[28:31], v2 offset:26624
    buffer_load_dword v160, v11, s[40:43], s87 offen offset:3072 sc1
    buffer_load_dword v161, v11, s[40:43], s87 offen offset:3328 sc1
    v_mfma_f32_32x32x16_bf16 v[180:195], v[232:235], v[72:75], v[180:195]
    ds_read_b128 v[228:231], v2 offset:59392
    buffer_load_dword v162, v11, s[40:43], s87 offen offset:3584 sc1
    buffer_load_dword v163, v11, s[40:43], s87 offen offset:3840 sc1
    s_waitcnt lgkmcnt(2)
    v_mfma_f32_32x32x16_bf16 v[196:211], v[236:239], v[44:47], v[196:211]
    ds_read_b128 v[232:235], v2 offset:27648
    s_add_u32 s55, s86, 0
    buffer_load_dwordx4 v[100:103], v2, s[40:43], s55 offen offset:0 sc1
    v_mfma_f32_32x32x16_bf16 v[212:227], v[20:23], v[44:47], v[212:227]
    ds_read_b128 v[236:239], v2 offset:60416
    s_waitcnt lgkmcnt(2)
    s_waitcnt vmcnt(22)
    v_mfma_f32_32x32x16_bf16 v[164:179], v[28:31], v[76:79], v[164:179]
    ds_read_b128 v[20:23], v33 offset:19456
    buffer_load_dwordx4 v[104:107], v2, s[40:43], s55 offen offset:1024 sc1
    v_mfma_f32_32x32x16_bf16 v[180:195], v[228:231], v[76:79], v[180:195]
    ds_read_b128 v[28:31], v33 offset:52224
    s_waitcnt lgkmcnt(2)
    s_waitcnt vmcnt(22)
    v_mfma_f32_32x32x16_bf16 v[164:179], v[232:235], v[80:83], v[164:179]
    ds_read_b128 v[228:231], v2 offset:28672
    buffer_load_dwordx4 v[108:111], v2, s[40:43], s55 offen offset:2048 sc1
    v_mfma_f32_32x32x16_bf16 v[180:195], v[236:239], v[80:83], v[180:195]
    ds_read_b128 v[232:235], v2 offset:61440
    s_waitcnt lgkmcnt(2)
    v_mfma_f32_32x32x16_bf16 v[196:211], v[20:23], v[48:51], v[196:211]
    ds_read_b128 v[236:239], v2 offset:29696
    buffer_load_dwordx4 v[112:115], v2, s[40:43], s55 offen offset:3072 sc1
    v_mfma_f32_32x32x16_bf16 v[212:227], v[28:31], v[48:51], v[212:227]
    ds_read_b128 v[20:23], v2 offset:62464
    s_waitcnt lgkmcnt(2)
    s_waitcnt vmcnt(23)
    v_mfma_f32_32x32x16_bf16 v[164:179], v[228:231], v[84:87], v[164:179]
    ds_read_b128 v[28:31], v33 offset:20480
    s_add_u32 s55, s86, 4096
    buffer_load_dwordx4 v[116:119], v2, s[40:43], s55 offen offset:0 sc1
    v_mfma_f32_32x32x16_bf16 v[180:195], v[232:235], v[84:87], v[180:195]
    ds_read_b128 v[228:231], v33 offset:53248
    s_waitcnt lgkmcnt(2)
    s_waitcnt vmcnt(23)
    v_mfma_f32_32x32x16_bf16 v[164:179], v[236:239], v[88:91], v[164:179]
    ds_read_b128 v[232:235], v2 offset:30720
    buffer_load_dwordx4 v[120:123], v2, s[40:43], s55 offen offset:1024 sc1
    v_mfma_f32_32x32x16_bf16 v[180:195], v[20:23], v[88:91], v[180:195]
    ds_read_b32 v26, v8 offset:640
    ds_read_b128 v[236:239], v2 offset:63488
    s_waitcnt lgkmcnt(3)
    v_mfma_f32_32x32x16_bf16 v[196:211], v[28:31], v[52:55], v[196:211]
    ds_read_b128 v[20:23], v2 offset:31744
    buffer_load_dwordx4 v[124:127], v2, s[40:43], s55 offen offset:2048 sc1
    v_mfma_f32_32x32x16_bf16 v[212:227], v[228:231], v[52:55], v[212:227]
    ds_read_b128 v[28:31], v2 offset:64512
    ds_write_b32 v6, v6 offset:96
    s_waitcnt lgkmcnt(3)
    s_waitcnt vmcnt(24)
    v_mfma_f32_32x32x16_bf16 v[164:179], v[232:235], v[92:95], v[164:179]
    ds_read_b128 v[228:231], v33 offset:21504
    buffer_load_dwordx4 v[128:131], v2, s[40:43], s55 offen offset:3072 sc1
    v_mfma_f32_32x32x16_bf16 v[180:195], v[236:239], v[92:95], v[180:195]
    v_cmp_eq_u32 vcc, 0, v26
    s_nop 0
    s_cbranch_vccnz L_ls_113
L_lb_114:
    ds_read_b128 v[232:235], v33 offset:54272
    s_waitcnt lgkmcnt(3)
    s_waitcnt vmcnt(24)
    v_mfma_f32_32x32x16_bf16 v[164:179], v[20:23], v[96:99], v[164:179]
    ds_read_b128 v[236:239], v2 offset:0
    s_add_u32 s55, s86, 8192
    buffer_load_dwordx4 v[132:135], v2, s[40:43], s55 offen offset:0 sc1
    v_mfma_f32_32x32x16_bf16 v[180:195], v[28:31], v[96:99], v[180:195]
    ds_read_b128 v[20:23], v2 offset:32768
    s_waitcnt lgkmcnt(2)
    v_mfma_f32_32x32x16_bf16 v[196:211], v[228:231], v[56:59], v[196:211]
    ds_read_b128 v[28:31], v2 offset:1024
    buffer_load_dwordx4 v[136:139], v2, s[40:43], s55 offen offset:1024 sc1
    s_waitcnt vmcnt(17)
    v_add_f32 v148, v148, v156
    s_waitcnt vmcnt(16)
    v_add_f32 v149, v149, v157
    s_waitcnt vmcnt(15)
    v_add_f32 v150, v150, v158
    s_waitcnt vmcnt(14)
    v_add_f32 v151, v151, v159
    v_mfma_f32_32x32x16_bf16 v[212:227], v[232:235], v[56:59], v[212:227]
    ds_read_b128 v[228:231], v2 offset:33792
    s_waitcnt vmcnt(13)
    v_add_f32 v152, v152, v160
    s_waitcnt vmcnt(12)
    v_add_f32 v153, v153, v161
    s_waitcnt vmcnt(11)
    v_add_f32 v154, v154, v162
    s_waitcnt vmcnt(10)
    v_add_f32 v155, v155, v163
    s_waitcnt lgkmcnt(2)
    s_waitcnt vmcnt(9)
    v_mfma_f32_32x32x16_bf16 v[164:179], v[236:239], v[100:103], v[164:179]
    ds_read_b128 v[232:235], v33 offset:22528
    buffer_load_dwordx4 v[140:143], v2, s[40:43], s55 offen offset:2048 sc1
    v_add_f32 v148, v148, v152
    v_add_f32 v149, v149, v153
    v_add_f32 v150, v150, v154
    v_add_f32 v151, v151, v155
    v_mfma_f32_32x32x16_bf16 v[180:195], v[20:23], v[100:103], v[180:195]
    ds_read_b128 v[236:239], v33 offset:55296
    v_add_f32 v148, v148, v150
    v_add_f32 v149, v149, v151
    v_add_f32 v148, v148, v149
    v_mov_b32 v149, v148
    s_waitcnt lgkmcnt(2)
    s_waitcnt vmcnt(9)
    v_mfma_f32_32x32x16_bf16 v[164:179], v[28:31], v[104:107], v[164:179]
    ds_read_b128 v[20:23], v2 offset:2048
    buffer_load_dwordx4 v[144:147], v2, s[40:43], s55 offen offset:3072 sc1
    v_permlane32_swap_b32 v148, v149
    v_mul_f32 v148, s60, v148
    v_mul_f32 v149, s60, v149
    v_mfma_f32_32x32x16_bf16 v[180:195], v[228:231], v[104:107], v[180:195]
    ds_read_b128 v[28:31], v2 offset:34816
    v_fma_f32 v149, -v148, v148, v149
    v_max_f32 v149, 0, v149
    v_cvt_pk_bf16_f32 v149, v149, v149
    v_and_b32 v149, 0xffff0000, v149
    s_waitcnt lgkmcnt(2)
    v_mfma_f32_32x32x16_bf16 v[196:211], v[232:235], v[60:63], v[196:211]
    ds_read_b128 v[228:231], v2 offset:3072
    v_add_f32 v149, 0x3727c5ac, v149
    v_cvt_pk_bf16_f32 v149, v149, v149
    v_and_b32 v149, 0xffff0000, v149
    v_sqrt_f32 v149, v149
    v_mfma_f32_32x32x16_bf16 v[212:227], v[236:239], v[60:63], v[212:227]
    ds_read_b128 v[232:235], v2 offset:35840
    v_cvt_pk_bf16_f32 v240, -v148, -v148
    v_cvt_pk_bf16_f32 v149, v149, v149
    v_and_b32 v149, 0xffff0000, v149
    s_waitcnt lgkmcnt(2)
    s_waitcnt vmcnt(9)
    v_mfma_f32_32x32x16_bf16 v[164:179], v[20:23], v[108:111], v[164:179]
    ds_read_b128 v[236:239], v33 offset:23552
    v_rcp_f32 v150, v149
    v_mul_f32 v0, v149, v149
    v_mul_f32 v252, 0xc0135761, v150
    v_mul_f32 v151, v150, v150
    v_mfma_f32_32x32x16_bf16 v[180:195], v[28:31], v[108:111], v[180:195]
    ds_read_b128 v[20:23], v33 offset:56320
    v_mul_f32 v253, 0x3d372713, v252
    v_mul_f32 v253, v151, v253
    v_mov_b32 v241, 0
    v_mov_b32 v242, v240
    s_waitcnt lgkmcnt(2)
    s_waitcnt vmcnt(8)
    v_mfma_f32_32x32x16_bf16 v[164:179], v[228:231], v[112:115], v[164:179]
    ds_read_b128 v[28:31], v2 offset:4096
    v_mov_b32 v243, 0
    v_mfma_f32_32x32x16_bf16 v[180:195], v[232:235], v[112:115], v[180:195]
    ds_read_b128 v[228:231], v2 offset:36864
    s_add_u32 s55, s86, 12288
    buffer_load_dwordx4 v[148:151], v2, s[40:43], s55 offen offset:0 sc1
    s_waitcnt lgkmcnt(2)
    v_mfma_f32_32x32x16_bf16 v[196:211], v[236:239], v[64:67], v[196:211]
    ds_read_b128 v[232:235], v2 offset:5120
    buffer_load_dwordx4 v[152:155], v2, s[40:43], s55 offen offset:1024 sc1
    v_mfma_f32_32x32x16_bf16 v[212:227], v[20:23], v[64:67], v[212:227]
    ds_read_b128 v[236:239], v2 offset:37888
    buffer_load_dwordx4 v[156:159], v2, s[40:43], s55 offen offset:2048 sc1
    s_waitcnt lgkmcnt(2)
    s_waitcnt vmcnt(10)
    v_mfma_f32_32x32x16_bf16 v[164:179], v[28:31], v[116:119], v[164:179]
    ds_read_b128 v[20:23], v33 offset:24576
    buffer_load_dwordx4 v[160:163], v2, s[40:43], s55 offen offset:3072 sc1
    v_mfma_f32_32x32x16_bf16 v[180:195], v[228:231], v[116:119], v[180:195]
    ds_read_b128 v[28:31], v33 offset:57344
    s_waitcnt lgkmcnt(2)
    s_waitcnt vmcnt(10)
    v_mfma_f32_32x32x16_bf16 v[164:179], v[232:235], v[120:123], v[164:179]
    ds_read_b128 v[228:231], v2 offset:6144
    s_lshl_b32 s4, s85, 4
    s_add_u32 s4, s4, 4125097984
    s_mov_b64 exec, 0xffff
    buffer_store_dwordx2 v[4:5], v9, s[40:43], s4 offen sc1
    s_mov_b64 exec, -1
    v_mfma_f32_32x32x16_bf16 v[180:195], v[236:239], v[120:123], v[180:195]
    ds_read_b128 v[232:235], v2 offset:38912
    s_waitcnt lgkmcnt(2)
    v_mfma_f32_32x32x16_bf16 v[196:211], v[20:23], v[68:71], v[196:211]
    ds_read_b128 v[236:239], v2 offset:7168
    v_mfma_f32_32x32x16_bf16 v[212:227], v[28:31], v[68:71], v[212:227]
    ds_read_b128 v[20:23], v2 offset:39936
    s_waitcnt lgkmcnt(2)
    s_waitcnt vmcnt(10)
    v_mfma_f32_32x32x16_bf16 v[164:179], v[228:231], v[124:127], v[164:179]
    ds_read_b128 v[28:31], v33 offset:25600
    v_mfma_f32_32x32x16_bf16 v[180:195], v[232:235], v[124:127], v[180:195]
    ds_read_b128 v[228:231], v33 offset:58368
    s_waitcnt lgkmcnt(2)
    s_waitcnt vmcnt(9)
    v_mfma_f32_32x32x16_bf16 v[164:179], v[236:239], v[128:131], v[164:179]
    ds_read_b128 v[232:235], v2 offset:8192
    v_mfma_f32_32x32x16_bf16 v[180:195], v[20:23], v[128:131], v[180:195]
    ds_read_b128 v[236:239], v2 offset:40960
    s_waitcnt lgkmcnt(2)
    v_mfma_f32_32x32x16_bf16 v[196:211], v[28:31], v[72:75], v[196:211]
    ds_read_b128 v[20:23], v2 offset:9216
    v_mfma_f32_32x32x16_bf16 v[212:227], v[228:231], v[72:75], v[212:227]
    ds_read_b128 v[28:31], v2 offset:41984
    s_waitcnt lgkmcnt(2)
    s_waitcnt vmcnt(8)
    v_mfma_f32_32x32x16_bf16 v[164:179], v[232:235], v[132:135], v[164:179]
    ds_read_b128 v[228:231], v33 offset:26624
    v_mfma_f32_32x32x16_bf16 v[180:195], v[236:239], v[132:135], v[180:195]
    ds_read_b128 v[232:235], v33 offset:59392
    s_waitcnt lgkmcnt(2)
    s_waitcnt vmcnt(7)
    v_mfma_f32_32x32x16_bf16 v[164:179], v[20:23], v[136:139], v[164:179]
    ds_read_b128 v[236:239], v2 offset:10240
    v_mfma_f32_32x32x16_bf16 v[180:195], v[28:31], v[136:139], v[180:195]
    ds_read_b128 v[20:23], v2 offset:43008
    s_waitcnt lgkmcnt(2)
    v_mfma_f32_32x32x16_bf16 v[196:211], v[228:231], v[76:79], v[196:211]
    ds_read_b128 v[28:31], v2 offset:11264
    v_mfma_f32_32x32x16_bf16 v[212:227], v[232:235], v[76:79], v[212:227]
    ds_read_b128 v[228:231], v2 offset:44032
    s_waitcnt lgkmcnt(2)
    s_waitcnt vmcnt(6)
    v_mfma_f32_32x32x16_bf16 v[164:179], v[236:239], v[140:143], v[164:179]
    ds_read_b128 v[232:235], v33 offset:27648
    v_mfma_f32_32x32x16_bf16 v[180:195], v[20:23], v[140:143], v[180:195]
    ds_read_b128 v[236:239], v33 offset:60416
    s_waitcnt lgkmcnt(2)
    s_waitcnt vmcnt(5)
    v_mfma_f32_32x32x16_bf16 v[164:179], v[28:31], v[144:147], v[164:179]
    ds_read_b128 v[20:23], v2 offset:12288
    v_mfma_f32_32x32x16_bf16 v[180:195], v[228:231], v[144:147], v[180:195]
    ds_read_b128 v[28:31], v2 offset:45056
    s_waitcnt lgkmcnt(2)
    v_mfma_f32_32x32x16_bf16 v[196:211], v[232:235], v[80:83], v[196:211]
    ds_read_b128 v[228:231], v2 offset:13312
    v_mfma_f32_32x32x16_bf16 v[212:227], v[236:239], v[80:83], v[212:227]
    ds_read_b128 v[232:235], v2 offset:46080
    s_waitcnt lgkmcnt(2)
    s_waitcnt vmcnt(4)
    v_mfma_f32_32x32x16_bf16 v[164:179], v[20:23], v[148:151], v[164:179]
    ds_read_b128 v[236:239], v33 offset:28672
    v_mfma_f32_32x32x16_bf16 v[180:195], v[28:31], v[148:151], v[180:195]
    ds_read_b32 v24, v8 offset:288
    ds_read_b128 v[20:23], v33 offset:61440
    s_waitcnt lgkmcnt(3)
    s_waitcnt vmcnt(3)
    v_mfma_f32_32x32x16_bf16 v[164:179], v[228:231], v[152:155], v[164:179]
    ds_read_b128 v[28:31], v2 offset:14336
    v_mfma_f32_32x32x16_bf16 v[180:195], v[232:235], v[152:155], v[180:195]
    ds_read_b128 v[228:231], v2 offset:47104
    s_waitcnt lgkmcnt(2)
    v_mfma_f32_32x32x16_bf16 v[196:211], v[236:239], v[84:87], v[196:211]
    ds_read_b128 v[232:235], v2 offset:15360
    v_mfma_f32_32x32x16_bf16 v[212:227], v[20:23], v[84:87], v[212:227]
    v_cmp_eq_u32 vcc, 0, v24
    s_nop 0
    s_cbranch_vccnz L_ls_125
L_lb_126:
    ds_read_b128 v[236:239], v2 offset:48128
    ds_write_b32 v6, v6 offset:624
    s_waitcnt lgkmcnt(3)
    s_waitcnt vmcnt(2)
    v_mfma_f32_32x32x16_bf16 v[164:179], v[28:31], v[156:159], v[164:179]
    ds_read_b128 v[20:23], v254 offset:0
    v_mfma_f32_32x32x16_bf16 v[180:195], v[228:231], v[156:159], v[180:195]
    ds_read_b128 v[28:31], v254 offset:1024
    s_waitcnt lgkmcnt(3)
    s_waitcnt vmcnt(1)
    v_mfma_f32_32x32x16_bf16 v[164:179], v[232:235], v[160:163], v[164:179]
    ds_read_b128 v[228:231], v33 offset:29696
    v_mfma_f32_32x32x16_bf16 v[180:195], v[236:239], v[160:163], v[180:195]
    ds_read_b32 v26, v8 offset:592
    ds_read_b128 v[232:235], v33 offset:62464
    s_waitcnt lgkmcnt(3)
    v_mfma_f32_32x32x16_bf16 v[164:179], v[20:23], v[240:243], v[164:179]
    ds_read_b128 v[236:239], v33 offset:30720
    v_mfma_f32_32x32x16_bf16 v[180:195], v[28:31], v[240:243], v[180:195]
    ds_read_b128 v[20:23], v33 offset:63488
    s_waitcnt lgkmcnt(2)
    v_mfma_f32_32x32x16_bf16 v[196:211], v[228:231], v[88:91], v[196:211]
    ds_read_b128 v[28:31], v33 offset:31744
    v_mfma_f32_32x32x16_bf16 v[212:227], v[232:235], v[88:91], v[212:227]
    v_cmp_eq_u32 vcc, 0, v26
    s_nop 0
    s_cbranch_vccnz L_ls_116
L_lb_117:
    ds_read_b128 v[228:231], v33 offset:64512
    s_waitcnt lgkmcnt(2)
    v_mfma_f32_32x32x16_bf16 v[196:211], v[236:239], v[92:95], v[196:211]
    ds_read_b128 v[232:235], v33 offset:0
    v_mul_f32 v244, v164, v164
    v_mul_f32 v245, v165, v165
    v_mul_f32 v246, v166, v166
    v_mul_f32 v247, v167, v167
    v_mul_f32 v248, v168, v168
    v_mul_f32 v249, v169, v169
    v_mfma_f32_32x32x16_bf16 v[212:227], v[20:23], v[92:95], v[212:227]
    ds_read_b128 v[236:239], v33 offset:32768
    v_mul_f32 v250, v170, v170
    v_mul_f32 v251, v171, v171
    v_fma_f32 v244, v244, v253, v252
    v_fma_f32 v245, v245, v253, v252
    v_fma_f32 v246, v246, v253, v252
    s_waitcnt lgkmcnt(2)
    v_mfma_f32_32x32x16_bf16 v[196:211], v[28:31], v[96:99], v[196:211]
    ds_read_b128 v[20:23], v33 offset:1024
    v_fma_f32 v247, v247, v253, v252
    v_fma_f32 v248, v248, v253, v252
    v_fma_f32 v249, v249, v253, v252
    v_fma_f32 v250, v250, v253, v252
    v_fma_f32 v251, v251, v253, v252
    v_mul_f32 v244, v164, v244
    v_mfma_f32_32x32x16_bf16 v[212:227], v[228:231], v[96:99], v[212:227]
    ds_read_b128 v[28:31], v33 offset:33792
    v_mul_f32 v245, v165, v245
    v_mul_f32 v246, v166, v246
    v_mul_f32 v247, v167, v247
    v_mul_f32 v248, v168, v248
    v_mul_f32 v249, v169, v249
    s_waitcnt lgkmcnt(2)
    v_mfma_f32_32x32x16_bf16 v[196:211], v[232:235], v[100:103], v[196:211]
    ds_read_b128 v[228:231], v33 offset:2048
    v_mul_f32 v250, v170, v250
    v_mul_f32 v251, v171, v251
    v_exp_f32 v244, v244
    v_mul_f32 v172, v164, v172
    v_mfma_f32_32x32x16_bf16 v[212:227], v[236:239], v[100:103], v[212:227]
    ds_read_b128 v[232:235], v33 offset:34816
    v_exp_f32 v245, v245
    v_mul_f32 v173, v165, v173
    v_exp_f32 v246, v246
    s_waitcnt lgkmcnt(2)
    v_mfma_f32_32x32x16_bf16 v[196:211], v[20:23], v[104:107], v[196:211]
    ds_read_b128 v[236:239], v33 offset:3072
    v_mul_f32 v174, v166, v174
    v_exp_f32 v247, v247
    v_mul_f32 v175, v167, v175
    v_exp_f32 v248, v248
    v_mfma_f32_32x32x16_bf16 v[212:227], v[28:31], v[104:107], v[212:227]
    ds_read_b128 v[20:23], v33 offset:35840
    v_mul_f32 v176, v168, v176
    v_exp_f32 v249, v249
    v_mul_f32 v177, v169, v177
    s_waitcnt lgkmcnt(2)
    v_mfma_f32_32x32x16_bf16 v[196:211], v[228:231], v[108:111], v[196:211]
    ds_read_b128 v[28:31], v33 offset:4096
    v_exp_f32 v250, v250
    v_mul_f32 v178, v170, v178
    v_exp_f32 v251, v251
    v_mul_f32 v179, v171, v179
    v_mfma_f32_32x32x16_bf16 v[212:227], v[232:235], v[108:111], v[212:227]
    ds_read_b128 v[228:231], v33 offset:36864
    v_fma_f32 v244, v244, v0, v0
    v_fma_f32 v245, v245, v0, v0
    v_fma_f32 v246, v246, v0, v0
    v_fma_f32 v247, v247, v0, v0
    v_fma_f32 v248, v248, v0, v0
    s_waitcnt lgkmcnt(2)
    v_mfma_f32_32x32x16_bf16 v[196:211], v[236:239], v[112:115], v[196:211]
    ds_read_b128 v[232:235], v33 offset:5120
    v_fma_f32 v249, v249, v0, v0
    v_fma_f32 v250, v250, v0, v0
    v_fma_f32 v251, v251, v0, v0
    v_rcp_f32 v244, v244
    v_mfma_f32_32x32x16_bf16 v[212:227], v[20:23], v[112:115], v[212:227]
    ds_read_b128 v[236:239], v33 offset:37888
    v_rcp_f32 v245, v245
    v_mul_f32 v172, v172, v244
    v_rcp_f32 v246, v246
    s_waitcnt lgkmcnt(2)
    v_mfma_f32_32x32x16_bf16 v[196:211], v[28:31], v[116:119], v[196:211]
    ds_read_b128 v[20:23], v33 offset:6144
    v_mul_f32 v173, v173, v245
    v_rcp_f32 v247, v247
    v_mul_f32 v174, v174, v246
    v_rcp_f32 v248, v248
    v_mfma_f32_32x32x16_bf16 v[212:227], v[228:231], v[116:119], v[212:227]
    ds_read_b128 v[28:31], v33 offset:38912
    v_mul_f32 v175, v175, v247
    v_rcp_f32 v249, v249
    v_mul_f32 v176, v176, v248
    s_waitcnt lgkmcnt(2)
    v_mfma_f32_32x32x16_bf16 v[196:211], v[232:235], v[120:123], v[196:211]
    ds_read_b128 v[228:231], v33 offset:7168
    v_rcp_f32 v250, v250
    v_mul_f32 v177, v177, v249
    v_rcp_f32 v251, v251
    v_mul_f32 v178, v178, v250
    v_mfma_f32_32x32x16_bf16 v[212:227], v[236:239], v[120:123], v[212:227]
    ds_read_b128 v[232:235], v33 offset:39936
    v_mul_f32 v179, v179, v251
    v_cvt_pk_bf16_f32 v164, v172, v173
    v_cvt_pk_bf16_f32 v165, v174, v175
    v_cvt_pk_bf16_f32 v166, v176, v177
    v_cvt_pk_bf16_f32 v167, v178, v179
    s_waitcnt lgkmcnt(2)
    v_mfma_f32_32x32x16_bf16 v[196:211], v[20:23], v[124:127], v[196:211]
    ds_read_b128 v[236:239], v33 offset:8192
    buffer_store_dwordx4 v[164:167], v2, s[40:43], s88 offen offset:0 sc1
    v_mul_f32 v244, v180, v180
    v_mul_f32 v245, v181, v181
    v_mul_f32 v246, v182, v182
    v_mul_f32 v247, v183, v183
    v_mul_f32 v248, v184, v184
    v_mfma_f32_32x32x16_bf16 v[212:227], v[28:31], v[124:127], v[212:227]
    ds_read_b128 v[20:23], v33 offset:40960
    v_mul_f32 v249, v185, v185
    v_mul_f32 v250, v186, v186
    v_mul_f32 v251, v187, v187
    v_fma_f32 v244, v244, v253, v252
    v_fma_f32 v245, v245, v253, v252
    s_waitcnt lgkmcnt(2)
    v_mfma_f32_32x32x16_bf16 v[196:211], v[228:231], v[128:131], v[196:211]
    ds_read_b128 v[28:31], v33 offset:9216
    v_fma_f32 v246, v246, v253, v252
    v_fma_f32 v247, v247, v253, v252
    v_fma_f32 v248, v248, v253, v252
    v_fma_f32 v249, v249, v253, v252
    v_fma_f32 v250, v250, v253, v252
    v_fma_f32 v251, v251, v253, v252
    v_mfma_f32_32x32x16_bf16 v[212:227], v[232:235], v[128:131], v[212:227]
    ds_read_b128 v[228:231], v33 offset:41984
    v_mul_f32 v244, v180, v244
    v_mul_f32 v245, v181, v245
    v_mul_f32 v246, v182, v246
    v_mul_f32 v247, v183, v247
    v_mul_f32 v248, v184, v248
    s_waitcnt lgkmcnt(2)
    v_mfma_f32_32x32x16_bf16 v[196:211], v[236:239], v[132:135], v[196:211]
    ds_read_b128 v[232:235], v33 offset:10240
    v_mul_f32 v249, v185, v249
    v_mul_f32 v250, v186, v250
    v_mul_f32 v251, v187, v251
    v_exp_f32 v244, v244
    v_mul_f32 v188, v180, v188
    v_mfma_f32_32x32x16_bf16 v[212:227], v[20:23], v[132:135], v[212:227]
    ds_read_b128 v[236:239], v33 offset:43008
    v_exp_f32 v245, v245
    v_mul_f32 v189, v181, v189
    v_exp_f32 v246, v246
    s_waitcnt lgkmcnt(2)
    v_mfma_f32_32x32x16_bf16 v[196:211], v[28:31], v[136:139], v[196:211]
    ds_read_b128 v[20:23], v33 offset:11264
    v_mul_f32 v190, v182, v190
    v_exp_f32 v247, v247
    v_mul_f32 v191, v183, v191
    v_exp_f32 v248, v248
    v_mfma_f32_32x32x16_bf16 v[212:227], v[228:231], v[136:139], v[212:227]
    ds_read_b128 v[28:31], v33 offset:44032
    v_mul_f32 v192, v184, v192
    v_exp_f32 v249, v249
    v_mul_f32 v193, v185, v193
    s_waitcnt lgkmcnt(2)
    v_mfma_f32_32x32x16_bf16 v[196:211], v[232:235], v[140:143], v[196:211]
    ds_read_b128 v[228:231], v33 offset:12288
    v_exp_f32 v250, v250
    v_mul_f32 v194, v186, v194
    v_exp_f32 v251, v251
    v_mul_f32 v195, v187, v195
    v_mfma_f32_32x32x16_bf16 v[212:227], v[236:239], v[140:143], v[212:227]
    ds_read_b128 v[232:235], v33 offset:45056
    v_fma_f32 v244, v244, v0, v0
    v_fma_f32 v245, v245, v0, v0
    v_fma_f32 v246, v246, v0, v0
    v_fma_f32 v247, v247, v0, v0
    v_fma_f32 v248, v248, v0, v0
    s_waitcnt lgkmcnt(2)
    v_mfma_f32_32x32x16_bf16 v[196:211], v[20:23], v[144:147], v[196:211]
    ds_read_b128 v[236:239], v33 offset:13312
    v_fma_f32 v249, v249, v0, v0
    v_fma_f32 v250, v250, v0, v0
    v_fma_f32 v251, v251, v0, v0
    v_rcp_f32 v244, v244
    v_mfma_f32_32x32x16_bf16 v[212:227], v[28:31], v[144:147], v[212:227]
    ds_read_b128 v[20:23], v33 offset:46080
    v_rcp_f32 v245, v245
    v_mul_f32 v188, v188, v244
    v_rcp_f32 v246, v246
    s_waitcnt lgkmcnt(2)
    v_mfma_f32_32x32x16_bf16 v[196:211], v[228:231], v[148:151], v[196:211]
    ds_read_b128 v[28:31], v33 offset:14336
    v_mul_f32 v189, v189, v245
    v_rcp_f32 v247, v247
    v_mul_f32 v190, v190, v246
    v_rcp_f32 v248, v248
    v_mfma_f32_32x32x16_bf16 v[212:227], v[232:235], v[148:151], v[212:227]
    ds_read_b32 v26, v8 offset:112
    ds_read_b128 v[228:231], v33 offset:47104
    v_mul_f32 v191, v191, v247
    v_rcp_f32 v249, v249
    v_mul_f32 v192, v192, v248
    s_waitcnt lgkmcnt(3)
    v_mfma_f32_32x32x16_bf16 v[196:211], v[236:239], v[152:155], v[196:211]
    ds_read_b128 v[232:235], v33 offset:15360
    v_rcp_f32 v250, v250
    v_mul_f32 v193, v193, v249
    v_rcp_f32 v251, v251
    v_mul_f32 v194, v194, v250
    v_mfma_f32_32x32x16_bf16 v[212:227], v[20:23], v[152:155], v[212:227]
    ds_read_b128 v[236:239], v33 offset:48128
    ds_write_b32 v6, v6 offset:128
    v_mul_f32 v195, v195, v251
    v_cvt_pk_bf16_f32 v180, v188, v189
    v_cvt_pk_bf16_f32 v181, v190, v191
    v_cvt_pk_bf16_f32 v182, v192, v193
    s_waitcnt lgkmcnt(3)
    v_mfma_f32_32x32x16_bf16 v[196:211], v[28:31], v[156:159], v[196:211]
    ds_read_b128 v[20:23], v254 offset:2048
    v_cvt_pk_bf16_f32 v183, v194, v195
    buffer_store_dwordx4 v[180:183], v2, s[40:43], s88 offen offset:1024 sc1
    v_mfma_f32_32x32x16_bf16 v[212:227], v[228:231], v[156:159], v[212:227]
    v_cmp_eq_u32 vcc, 0, v26
    s_nop 0
    s_cbranch_vccnz L_ls_119
L_lb_120:
    ds_read_b128 v[28:31], v254 offset:3072
    s_waitcnt lgkmcnt(3)
    v_mfma_f32_32x32x16_bf16 v[196:211], v[232:235], v[160:163], v[196:211]
    ds_read_b128 v[228:231], v2 offset:16384
    v_mfma_f32_32x32x16_bf16 v[212:227], v[236:239], v[160:163], v[212:227]
    ds_read_b128 v[232:235], v2 offset:49152
    s_waitcnt lgkmcnt(2)
    v_mfma_f32_32x32x16_bf16 v[196:211], v[20:23], v[240:243], v[196:211]
    ds_read_b128 v[236:239], v2 offset:17408
    v_mfma_f32_32x32x16_bf16 v[212:227], v[28:31], v[240:243], v[212:227]
    ds_read_b128 v[20:23], v2 offset:50176
    s_waitcnt lgkmcnt(2)
    v_mfma_f32_32x32x16_bf16 v[164:179], v[228:231], v[36:39], 0
    ds_read_b128 v[28:31], v2 offset:18432
    v_mfma_f32_32x32x16_bf16 v[180:195], v[232:235], v[36:39], 0
    ds_read_b128 v[228:231], v2 offset:51200
    s_waitcnt lgkmcnt(2)
    v_mfma_f32_32x32x16_bf16 v[164:179], v[236:239], v[40:43], v[164:179]
    ds_read_b128 v[232:235], v2 offset:19456
    s_nop 0
    v_mul_f32 v244, v196, v196
    v_mul_f32 v245, v197, v197
    v_mul_f32 v246, v198, v198
    v_mul_f32 v247, v199, v199
    v_mul_f32 v248, v200, v200
    v_mfma_f32_32x32x16_bf16 v[180:195], v[20:23], v[40:43], v[180:195]
    ds_read_b128 v[236:239], v2 offset:52224
    v_mul_f32 v249, v201, v201
    v_mul_f32 v250, v202, v202
    v_mul_f32 v251, v203, v203
    v_fma_f32 v244, v244, v253, v252
    s_waitcnt lgkmcnt(2)
    v_mfma_f32_32x32x16_bf16 v[164:179], v[28:31], v[44:47], v[164:179]
    ds_read_b128 v[20:23], v2 offset:20480
    v_fma_f32 v245, v245, v253, v252
    v_fma_f32 v246, v246, v253, v252
    v_fma_f32 v247, v247, v253, v252
    v_fma_f32 v248, v248, v253, v252
    v_fma_f32 v249, v249, v253, v252
    v_mfma_f32_32x32x16_bf16 v[180:195], v[228:231], v[44:47], v[180:195]
    ds_read_b128 v[28:31], v2 offset:53248
    v_fma_f32 v250, v250, v253, v252
    v_fma_f32 v251, v251, v253, v252
    v_mul_f32 v244, v196, v244
    v_mul_f32 v245, v197, v245
    s_waitcnt lgkmcnt(2)
    v_mfma_f32_32x32x16_bf16 v[164:179], v[232:235], v[48:51], v[164:179]
    ds_read_b128 v[228:231], v2 offset:21504
    v_mul_f32 v246, v198, v246
    v_mul_f32 v247, v199, v247
    v_mul_f32 v248, v200, v248
    v_mul_f32 v249, v201, v249
    v_mul_f32 v250, v202, v250
    v_mfma_f32_32x32x16_bf16 v[180:195], v[236:239], v[48:51], v[180:195]
    ds_read_b128 v[232:235], v2 offset:54272
    v_mul_f32 v251, v203, v251
    v_exp_f32 v244, v244
    v_mul_f32 v204, v196, v204
    s_waitcnt lgkmcnt(2)
    v_mfma_f32_32x32x16_bf16 v[164:179], v[20:23], v[52:55], v[164:179]
    ds_read_b128 v[236:239], v2 offset:22528
    v_exp_f32 v245, v245
    v_mul_f32 v205, v197, v205
    v_exp_f32 v246, v246
    v_mfma_f32_32x32x16_bf16 v[180:195], v[28:31], v[52:55], v[180:195]
    ds_read_b128 v[20:23], v2 offset:55296
    v_mul_f32 v206, v198, v206
    v_exp_f32 v247, v247
    v_mul_f32 v207, v199, v207
    s_waitcnt lgkmcnt(2)
    v_mfma_f32_32x32x16_bf16 v[164:179], v[228:231], v[56:59], v[164:179]
    ds_read_b128 v[28:31], v2 offset:23552
    v_exp_f32 v248, v248
    v_mul_f32 v208, v200, v208
    v_exp_f32 v249, v249
    v_mfma_f32_32x32x16_bf16 v[180:195], v[232:235], v[56:59], v[180:195]
    ds_read_b128 v[228:231], v2 offset:56320
    v_mul_f32 v209, v201, v209
    v_exp_f32 v250, v250
    v_mul_f32 v210, v202, v210
    s_waitcnt lgkmcnt(2)
    v_mfma_f32_32x32x16_bf16 v[164:179], v[236:239], v[60:63], v[164:179]
    ds_read_b128 v[232:235], v2 offset:24576
    v_exp_f32 v251, v251
    v_mul_f32 v211, v203, v211
    v_fma_f32 v244, v244, v0, v0
    v_fma_f32 v245, v245, v0, v0
    v_mfma_f32_32x32x16_bf16 v[180:195], v[20:23], v[60:63], v[180:195]
    ds_read_b128 v[236:239], v2 offset:57344
    v_fma_f32 v246, v246, v0, v0
    v_fma_f32 v247, v247, v0, v0
    v_fma_f32 v248, v248, v0, v0
    v_fma_f32 v249, v249, v0, v0
    s_waitcnt lgkmcnt(2)
    v_mfma_f32_32x32x16_bf16 v[164:179], v[28:31], v[64:67], v[164:179]
    ds_read_b128 v[20:23], v2 offset:25600
    v_fma_f32 v250, v250, v0, v0
    v_fma_f32 v251, v251, v0, v0
    v_rcp_f32 v244, v244
    s_waitcnt vmcnt(0)
    s_mov_b64 exec, 1
    buffer_store_dwordx2 v[4:5], v10, s[40:43], s89 offen offset:0
    s_mov_b64 exec, -1
    s_lshl_b32 s4, s89, 4
    s_add_u32 s4, s4, 4125097984
    s_mov_b64 exec, 0xffff
    buffer_store_dwordx2 v[4:5], v9, s[40:43], s4 offen sc1
    s_mov_b64 exec, -1
    v_mfma_f32_32x32x16_bf16 v[180:195], v[228:231], v[64:67], v[180:195]
    ds_read_b128 v[28:31], v2 offset:58368
    v_rcp_f32 v245, v245
    v_mul_f32 v204, v204, v244
    s_waitcnt lgkmcnt(2)
    v_mfma_f32_32x32x16_bf16 v[164:179], v[232:235], v[68:71], v[164:179]
    ds_read_b128 v[228:231], v2 offset:26624
    v_rcp_f32 v246, v246
    v_mul_f32 v205, v205, v245
    v_rcp_f32 v247, v247
    v_mfma_f32_32x32x16_bf16 v[180:195], v[236:239], v[68:71], v[180:195]
    ds_read_b128 v[232:235], v2 offset:59392
    v_mul_f32 v206, v206, v246
    v_rcp_f32 v248, v248
    v_mul_f32 v207, v207, v247
    s_waitcnt lgkmcnt(2)
    v_mfma_f32_32x32x16_bf16 v[164:179], v[20:23], v[72:75], v[164:179]
    ds_read_b128 v[236:239], v2 offset:27648
    v_rcp_f32 v249, v249
    v_mul_f32 v208, v208, v248
    v_rcp_f32 v250, v250
    v_mfma_f32_32x32x16_bf16 v[180:195], v[28:31], v[72:75], v[180:195]
    ds_read_b128 v[20:23], v2 offset:60416
    v_mul_f32 v209, v209, v249
    v_rcp_f32 v251, v251
    v_mul_f32 v210, v210, v250
    s_waitcnt lgkmcnt(2)
    v_mfma_f32_32x32x16_bf16 v[164:179], v[228:231], v[76:79], v[164:179]
    ds_read_b128 v[28:31], v2 offset:28672
    v_mul_f32 v211, v211, v251
    v_cvt_pk_bf16_f32 v196, v204, v205
    v_cvt_pk_bf16_f32 v197, v206, v207
    v_cvt_pk_bf16_f32 v198, v208, v209
    v_cvt_pk_bf16_f32 v199, v210, v211
    v_mfma_f32_32x32x16_bf16 v[180:195], v[232:235], v[76:79], v[180:195]
    ds_read_b128 v[228:231], v2 offset:61440
    buffer_store_dwordx4 v[196:199], v2, s[40:43], s88 offen offset:2048 sc1
    v_mul_f32 v244, v212, v212
    v_mul_f32 v245, v213, v213
    v_mul_f32 v246, v214, v214
    s_waitcnt lgkmcnt(2)
    v_mfma_f32_32x32x16_bf16 v[164:179], v[236:239], v[80:83], v[164:179]
    ds_read_b128 v[232:235], v2 offset:29696
    v_mul_f32 v247, v215, v215
    v_mul_f32 v248, v216, v216
    v_mul_f32 v249, v217, v217
    v_mul_f32 v250, v218, v218
    v_mul_f32 v251, v219, v219
    v_mfma_f32_32x32x16_bf16 v[180:195], v[20:23], v[80:83], v[180:195]
    ds_read_b32 v26, v8 offset:608
    ds_read_b128 v[236:239], v2 offset:62464
    v_fma_f32 v244, v244, v253, v252
    v_fma_f32 v245, v245, v253, v252
    v_fma_f32 v246, v246, v253, v252
    s_waitcnt lgkmcnt(3)
    v_mfma_f32_32x32x16_bf16 v[164:179], v[28:31], v[84:87], v[164:179]
    ds_read_b128 v[20:23], v2 offset:30720
    v_fma_f32 v247, v247, v253, v252
    v_fma_f32 v248, v248, v253, v252
    v_fma_f32 v249, v249, v253, v252
    v_fma_f32 v250, v250, v253, v252
    v_fma_f32 v251, v251, v253, v252
    buffer_load_dwordx2 v[24:25], v35, s[40:43], 0 offen offset:0 sc1
    v_mfma_f32_32x32x16_bf16 v[180:195], v[228:231], v[84:87], v[180:195]
    ds_read_b128 v[28:31], v2 offset:63488
    v_mul_f32 v244, v212, v244
    v_mul_f32 v245, v213, v245
    v_mul_f32 v246, v214, v246
    v_mul_f32 v247, v215, v247
    s_waitcnt lgkmcnt(2)
    v_mfma_f32_32x32x16_bf16 v[164:179], v[232:235], v[88:91], v[164:179]
    ds_read_b128 v[228:231], v2 offset:31744
    v_mul_f32 v248, v216, v248
    v_mul_f32 v249, v217, v249
    v_mul_f32 v250, v218, v250
    v_mul_f32 v251, v219, v251
    v_mfma_f32_32x32x16_bf16 v[180:195], v[236:239], v[88:91], v[180:195]
    v_cmp_eq_u32 vcc, 0, v26
    s_nop 0
    s_cbranch_vccnz L_ls_122
L_lb_123:
    ds_read_b128 v[232:235], v2 offset:64512
    v_exp_f32 v244, v244
    s_waitcnt lgkmcnt(2)
    v_mfma_f32_32x32x16_bf16 v[164:179], v[20:23], v[92:95], v[164:179]
    ds_read_b128 v[236:239], v2 offset:0
    v_mul_f32 v220, v212, v220
    v_exp_f32 v245, v245
    v_mul_f32 v221, v213, v221
    v_mfma_f32_32x32x16_bf16 v[180:195], v[28:31], v[92:95], v[180:195]
    ds_read_b128 v[20:23], v2 offset:32768
    v_exp_f32 v246, v246
    v_mul_f32 v222, v214, v222
    s_waitcnt lgkmcnt(2)
    v_mfma_f32_32x32x16_bf16 v[164:179], v[228:231], v[96:99], v[164:179]
    ds_read_b128 v[28:31], v2 offset:1024
    v_exp_f32 v247, v247
    v_mul_f32 v223, v215, v223
    v_exp_f32 v248, v248
    v_mfma_f32_32x32x16_bf16 v[180:195], v[232:235], v[96:99], v[180:195]
    ds_read_b128 v[228:231], v2 offset:33792
    v_mul_f32 v224, v216, v224
    v_exp_f32 v249, v249
    v_mul_f32 v225, v217, v225
    s_waitcnt lgkmcnt(2)
    v_mfma_f32_32x32x16_bf16 v[164:179], v[236:239], v[100:103], v[164:179]
    ds_read_b128 v[232:235], v2 offset:2048
    v_exp_f32 v250, v250
    v_mul_f32 v226, v218, v226
    v_exp_f32 v251, v251
    v_mfma_f32_32x32x16_bf16 v[180:195], v[20:23], v[100:103], v[180:195]
    ds_read_b128 v[236:239], v2 offset:34816
    v_mul_f32 v227, v219, v227
    v_fma_f32 v244, v244, v0, v0
    v_fma_f32 v245, v245, v0, v0
    v_fma_f32 v246, v246, v0, v0
    s_waitcnt lgkmcnt(2)
    v_mfma_f32_32x32x16_bf16 v[164:179], v[28:31], v[104:107], v[164:179]
    ds_read_b128 v[20:23], v2 offset:3072
    v_fma_f32 v247, v247, v0, v0
    v_fma_f32 v248, v248, v0, v0
    v_fma_f32 v249, v249, v0, v0
    v_fma_f32 v250, v250, v0, v0
    v_fma_f32 v251, v251, v0, v0
    v_mfma_f32_32x32x16_bf16 v[180:195], v[228:231], v[104:107], v[180:195]
    ds_read_b128 v[28:31], v2 offset:35840
    v_rcp_f32 v244, v244
    v_rcp_f32 v245, v245
    s_waitcnt lgkmcnt(2)
    v_mfma_f32_32x32x16_bf16 v[164:179], v[232:235], v[108:111], v[164:179]
    ds_read_b128 v[228:231], v2 offset:4096
    v_mul_f32 v220, v220, v244
    v_rcp_f32 v246, v246
    v_mul_f32 v221, v221, v245
    s_mul_i32 s5, s44, 6144
    s_add_u32 s5, s5, 131072
    v_add_u32 v255, s5, v32
    v_xor_b32 v11, 64, v255
    v_mfma_f32_32x32x16_bf16 v[180:195], v[236:239], v[108:111], v[180:195]
    ds_read_b128 v[232:235], v2 offset:36864
    v_rcp_f32 v247, v247
    v_mul_f32 v222, v222, v246
    s_waitcnt lgkmcnt(2)
    v_mfma_f32_32x32x16_bf16 v[164:179], v[20:23], v[112:115], v[164:179]
    ds_read_b128 v[236:239], v2 offset:5120
    v_rcp_f32 v248, v248
    v_mul_f32 v223, v223, v247
    v_rcp_f32 v249, v249
    s_cmp_ge_u32 s44, 2
    s_cselect_b32 s5, 0x80000000, 0
    v_or_b32 v34, s5, v2
    v_mfma_f32_32x32x16_bf16 v[180:195], v[28:31], v[112:115], v[180:195]
    ds_read_b128 v[20:23], v2 offset:37888
    v_mul_f32 v224, v224, v248
    v_rcp_f32 v250, v250
    v_mul_f32 v225, v225, v249
    s_waitcnt lgkmcnt(2)
    v_mfma_f32_32x32x16_bf16 v[164:179], v[228:231], v[116:119], v[164:179]
    ds_read_b128 v[28:31], v2 offset:6144
    v_rcp_f32 v251, v251
    v_mul_f32 v226, v226, v250
    v_mul_f32 v227, v227, v251
    v_cvt_pk_bf16_f32 v212, v220, v221
    s_waitcnt vmcnt(0)
    v_cmp_ne_u64 vcc, s[70:71], v[24:25]
    s_nop 0
    s_cbranch_vccnz L_as_134
L_ab_135:
    v_mfma_f32_32x32x16_bf16 v[180:195], v[232:235], v[116:119], v[180:195]
    ds_read_b128 v[228:231], v2 offset:38912
    v_cvt_pk_bf16_f32 v213, v222, v223
    v_cvt_pk_bf16_f32 v214, v224, v225
    v_cvt_pk_bf16_f32 v215, v226, v227
    buffer_store_dwordx4 v[212:215], v2, s[40:43], s88 offen offset:3072 sc1
    s_add_u32 s3, s82, 0
    buffer_load_dwordx4 v[84:87], v2, s[40:43], s3 offen sc1
    s_waitcnt lgkmcnt(2)
    v_mfma_f32_32x32x16_bf16 v[164:179], v[236:239], v[120:123], v[164:179]
    ds_read_b128 v[232:235], v2 offset:7168
    v_lshlrev_b32 v36, 16, v12
    v_and_b32 v37, 0xffff0000, v12
    v_lshlrev_b32 v38, 16, v13
    v_and_b32 v39, 0xffff0000, v13
    v_lshlrev_b32 v40, 16, v14
    v_and_b32 v41, 0xffff0000, v14
    v_lshlrev_b32 v42, 16, v15
    v_mfma_f32_32x32x16_bf16 v[180:195], v[20:23], v[120:123], v[180:195]
    ds_read_b128 v[236:239], v2 offset:39936
    s_add_u32 s3, s81, 0
    buffer_load_dwordx4 v[88:91], v2, s[40:43], s3 offen sc1
    v_and_b32 v43, 0xffff0000, v15
    v_lshlrev_b32 v44, 16, v16
    v_and_b32 v45, 0xffff0000, v16
    v_lshlrev_b32 v46, 16, v17
    s_waitcnt lgkmcnt(2)
    v_mfma_f32_32x32x16_bf16 v[164:179], v[28:31], v[124:127], v[164:179]
    ds_read_b128 v[20:23], v2 offset:8192
    ds_read_b32 v26, v7 offset:160
    v_and_b32 v47, 0xffff0000, v17
    v_lshlrev_b32 v48, 16, v18
    v_and_b32 v49, 0xffff0000, v18
    v_lshlrev_b32 v50, 16, v19
    v_and_b32 v51, 0xffff0000, v19
    v_mfma_f32_32x32x16_bf16 v[180:195], v[228:231], v[124:127], v[180:195]
    ds_read_b128 v[28:31], v2 offset:40960
    s_add_u32 s3, s82, 12288
    buffer_load_dwordx4 v[92:95], v2, s[40:43], s3 offen sc1
    s_waitcnt lgkmcnt(3)
    v_mfma_f32_32x32x16_bf16 v[164:179], v[232:235], v[128:131], v[164:179]
    ds_read_b128 v[228:231], v2 offset:9216
    v_mfma_f32_32x32x16_bf16 v[180:195], v[236:239], v[128:131], v[180:195]
    ds_read_b128 v[232:235], v2 offset:41984
    s_add_u32 s3, s81, 12288
    buffer_load_dwordx4 v[96:99], v2, s[40:43], s3 offen sc1
    s_waitcnt lgkmcnt(2)
    v_mfma_f32_32x32x16_bf16 v[164:179], v[20:23], v[132:135], v[164:179]
    ds_read_b128 v[236:239], v2 offset:10240
    v_mfma_f32_32x32x16_bf16 v[180:195], v[28:31], v[132:135], v[180:195]
    ds_read_b128 v[20:23], v2 offset:43008
    s_add_u32 s3, s82, 24576
    buffer_load_dwordx4 v[100:103], v2, s[40:43], s3 offen sc1
    s_waitcnt lgkmcnt(2)
    v_mfma_f32_32x32x16_bf16 v[164:179], v[228:231], v[136:139], v[164:179]
    ds_read_b128 v[28:31], v2 offset:11264
    v_cmp_eq_u32 vcc, 0, v26
    s_nop 0
    s_cbranch_vccnz L_ls_140
L_lb_141:
    v_mfma_f32_32x32x16_bf16 v[180:195], v[232:235], v[136:139], v[180:195]
    ds_read_b128 v[228:231], v2 offset:44032
    s_add_u32 s3, s81, 24576
    buffer_load_dwordx4 v[104:107], v2, s[40:43], s3 offen sc1
    s_waitcnt lgkmcnt(2)
    v_mfma_f32_32x32x16_bf16 v[164:179], v[236:239], v[140:143], v[164:179]
    ds_read_b128 v[232:235], v2 offset:12288
    ds_read_b64_tr_b16 v[52:53], v255 offset:0
    v_mfma_f32_32x32x16_bf16 v[180:195], v[20:23], v[140:143], v[180:195]
    ds_read_b128 v[236:239], v2 offset:45056
    s_add_u32 s3, s82, 36864
    buffer_load_dwordx4 v[108:111], v2, s[40:43], s3 offen sc1
    ds_read_b64_tr_b16 v[54:55], v255 offset:512
    s_waitcnt lgkmcnt(4)
    v_mfma_f32_32x32x16_bf16 v[164:179], v[28:31], v[144:147], v[164:179]
    ds_read_b128 v[20:23], v2 offset:13312
    ds_read_b64_tr_b16 v[56:57], v11 offset:0
    v_mfma_f32_32x32x16_bf16 v[180:195], v[228:231], v[144:147], v[180:195]
    ds_read_b128 v[28:31], v2 offset:46080
    s_add_u32 s3, s81, 36864
    buffer_load_dwordx4 v[112:115], v2, s[40:43], s3 offen sc1
    ds_read_b64_tr_b16 v[58:59], v11 offset:512
    s_waitcnt lgkmcnt(5)
    v_mfma_f32_32x32x16_bf16 v[164:179], v[232:235], v[148:151], v[164:179]
    ds_read_b128 v[228:231], v2 offset:14336
    ds_read_b64_tr_b16 v[60:61], v255 offset:2048
    v_mfma_f32_32x32x16_bf16 v[180:195], v[236:239], v[148:151], v[180:195]
    ds_read_b128 v[232:235], v2 offset:47104
    s_add_u32 s3, s82, 49152
    buffer_load_dwordx4 v[196:199], v2, s[40:43], s3 offen sc1
    ds_read_b64_tr_b16 v[62:63], v255 offset:2560
    s_waitcnt lgkmcnt(5)
    v_mfma_f32_32x32x16_bf16 v[164:179], v[20:23], v[152:155], v[164:179]
    ds_read_b128 v[236:239], v2 offset:15360
    s_add_u32 s3, s81, 49152
    buffer_load_dwordx4 v[200:203], v2, s[40:43], s3 offen sc1
    ds_read_b64_tr_b16 v[64:65], v11 offset:2048
    v_mfma_f32_32x32x16_bf16 v[180:195], v[28:31], v[152:155], v[180:195]
    ds_read_b128 v[20:23], v2 offset:48128
    ds_write_b32 v6, v6 offset:144
    s_add_u32 s3, s82, 61440
    buffer_load_dwordx4 v[204:207], v2, s[40:43], s3 offen sc1
    ds_read_b64_tr_b16 v[66:67], v11 offset:2560
    s_waitcnt lgkmcnt(6)
    v_mfma_f32_32x32x16_bf16 v[164:179], v[228:231], v[156:159], v[164:179]
    ds_read_b128 v[28:31], v254 offset:4096
    s_add_u32 s3, s81, 61440
    buffer_load_dwordx4 v[208:211], v2, s[40:43], s3 offen sc1
    ds_read_b64_tr_b16 v[68:69], v255 offset:4096
    v_mfma_f32_32x32x16_bf16 v[180:195], v[232:235], v[156:159], v[180:195]
    ds_read_b128 v[228:231], v254 offset:5120
    ds_read_b64_tr_b16 v[70:71], v255 offset:4608
    s_waitcnt lgkmcnt(6)
    v_mfma_f32_32x32x16_bf16 v[164:179], v[236:239], v[160:163], v[164:179]
    ds_read_b64_tr_b16 v[72:73], v11 offset:4096
    v_mfma_f32_32x32x16_bf16 v[180:195], v[20:23], v[160:163], v[180:195]
    ds_read_b64_tr_b16 v[74:75], v11 offset:4608
    ds_write_b32 v6, v6 offset:224
    s_waitcnt lgkmcnt(4)
    v_mfma_f32_32x32x16_bf16 v[164:179], v[28:31], v[240:243], v[164:179]
    v_mfma_f32_32x32x16_bf16 v[180:195], v[228:231], v[240:243], v[180:195]
    s_waitcnt vmcnt(12)
    s_mov_b64 exec, 1
    buffer_store_dwordx2 v[4:5], v10, s[40:43], s89 offen offset:128
    s_mov_b64 exec, -1
    s_nop 6
    v_pk_mul_f32 v[244:245], v[164:165], v[164:165]
    v_pk_mul_f32 v[246:247], v[166:167], v[166:167]
    v_pk_mul_f32 v[248:249], v[168:169], v[168:169]
    v_pk_mul_f32 v[250:251], v[170:171], v[170:171]
    v_pk_fma_f32 v[244:245], v[244:245], v[252:253], v[252:253] op_sel:[0,1,0] op_sel_hi:[1,1,0]
    v_pk_fma_f32 v[246:247], v[246:247], v[252:253], v[252:253] op_sel:[0,1,0] op_sel_hi:[1,1,0]
    v_pk_fma_f32 v[248:249], v[248:249], v[252:253], v[252:253] op_sel:[0,1,0] op_sel_hi:[1,1,0]
    v_pk_fma_f32 v[250:251], v[250:251], v[252:253], v[252:253] op_sel:[0,1,0] op_sel_hi:[1,1,0]
    v_pk_mul_f32 v[244:245], v[164:165], v[244:245]
    v_pk_mul_f32 v[246:247], v[166:167], v[246:247]
    v_pk_mul_f32 v[248:249], v[168:169], v[248:249]
    v_pk_mul_f32 v[250:251], v[170:171], v[250:251]
    v_exp_f32 v244, v244
    v_exp_f32 v245, v245
    v_exp_f32 v246, v246
    v_exp_f32 v247, v247
    v_exp_f32 v248, v248
    v_exp_f32 v249, v249
    v_exp_f32 v250, v250
    v_exp_f32 v251, v251
    v_pk_mul_f32 v[172:173], v[164:165], v[172:173]
    v_pk_mul_f32 v[174:175], v[166:167], v[174:175]
    v_pk_mul_f32 v[176:177], v[168:169], v[176:177]
    v_pk_mul_f32 v[178:179], v[170:171], v[178:179]
    v_pk_fma_f32 v[244:245], v[244:245], v[0:1], v[0:1] op_sel:[0,0,0] op_sel_hi:[1,0,0]
    v_pk_fma_f32 v[246:247], v[246:247], v[0:1], v[0:1] op_sel:[0,0,0] op_sel_hi:[1,0,0]
    v_pk_fma_f32 v[248:249], v[248:249], v[0:1], v[0:1] op_sel:[0,0,0] op_sel_hi:[1,0,0]
    v_pk_fma_f32 v[250:251], v[250:251], v[0:1], v[0:1] op_sel:[0,0,0] op_sel_hi:[1,0,0]
    v_rcp_f32 v244, v244
    v_rcp_f32 v245, v245
    v_rcp_f32 v246, v246
    v_rcp_f32 v247, v247
    v_rcp_f32 v248, v248
    v_rcp_f32 v249, v249
    v_rcp_f32 v250, v250
    v_rcp_f32 v251, v251
    v_pk_mul_f32 v[172:173], v[172:173], v[244:245]
    v_pk_mul_f32 v[174:175], v[174:175], v[246:247]
    v_pk_mul_f32 v[176:177], v[176:177], v[248:249]
    v_pk_mul_f32 v[178:179], v[178:179], v[250:251]
    v_cvt_pk_bf16_f32 v164, v172, v173
    v_cvt_pk_bf16_f32 v165, v174, v175
    v_cvt_pk_bf16_f32 v166, v176, v177
    v_cvt_pk_bf16_f32 v167, v178, v179
    buffer_store_dwordx4 v[164:167], v2, s[40:43], s54 offen offset:0 sc1
    v_pk_mul_f32 v[244:245], v[180:181], v[180:181]
    v_pk_mul_f32 v[246:247], v[182:183], v[182:183]
    v_pk_mul_f32 v[248:249], v[184:185], v[184:185]
    v_pk_mul_f32 v[250:251], v[186:187], v[186:187]
    v_pk_fma_f32 v[244:245], v[244:245], v[252:253], v[252:253] op_sel:[0,1,0] op_sel_hi:[1,1,0]
    v_pk_fma_f32 v[246:247], v[246:247], v[252:253], v[252:253] op_sel:[0,1,0] op_sel_hi:[1,1,0]
    v_pk_fma_f32 v[248:249], v[248:249], v[252:253], v[252:253] op_sel:[0,1,0] op_sel_hi:[1,1,0]
    v_pk_fma_f32 v[250:251], v[250:251], v[252:253], v[252:253] op_sel:[0,1,0] op_sel_hi:[1,1,0]
    v_pk_mul_f32 v[244:245], v[180:181], v[244:245]
    v_pk_mul_f32 v[246:247], v[182:183], v[246:247]
    v_pk_mul_f32 v[248:249], v[184:185], v[248:249]
    v_pk_mul_f32 v[250:251], v[186:187], v[250:251]
    v_exp_f32 v244, v244
    v_exp_f32 v245, v245
    v_exp_f32 v246, v246
    v_exp_f32 v247, v247
    v_exp_f32 v248, v248
    v_exp_f32 v249, v249
    v_exp_f32 v250, v250
    v_exp_f32 v251, v251
    v_pk_mul_f32 v[188:189], v[180:181], v[188:189]
    v_pk_mul_f32 v[190:191], v[182:183], v[190:191]
    v_pk_mul_f32 v[192:193], v[184:185], v[192:193]
    v_pk_mul_f32 v[194:195], v[186:187], v[194:195]
    v_pk_fma_f32 v[244:245], v[244:245], v[0:1], v[0:1] op_sel:[0,0,0] op_sel_hi:[1,0,0]
    v_pk_fma_f32 v[246:247], v[246:247], v[0:1], v[0:1] op_sel:[0,0,0] op_sel_hi:[1,0,0]
    v_pk_fma_f32 v[248:249], v[248:249], v[0:1], v[0:1] op_sel:[0,0,0] op_sel_hi:[1,0,0]
    v_pk_fma_f32 v[250:251], v[250:251], v[0:1], v[0:1] op_sel:[0,0,0] op_sel_hi:[1,0,0]
    v_rcp_f32 v244, v244
    v_rcp_f32 v245, v245
    v_rcp_f32 v246, v246
    v_rcp_f32 v247, v247
    v_rcp_f32 v248, v248
    v_rcp_f32 v249, v249
    v_rcp_f32 v250, v250
    v_rcp_f32 v251, v251
    v_pk_mul_f32 v[188:189], v[188:189], v[244:245]
    v_pk_mul_f32 v[190:191], v[190:191], v[246:247]
    v_pk_mul_f32 v[192:193], v[192:193], v[248:249]
    v_pk_mul_f32 v[194:195], v[194:195], v[250:251]
    v_cvt_pk_bf16_f32 v180, v188, v189
    v_cvt_pk_bf16_f32 v181, v190, v191
    v_cvt_pk_bf16_f32 v182, v192, v193
    v_cvt_pk_bf16_f32 v183, v194, v195
    buffer_store_dwordx4 v[180:183], v2, s[40:43], s54 offen offset:1024 sc1
    s_lshl_b32 s4, s89, 4
    s_add_u32 s4, s4, 4125100032
    s_mov_b64 exec, 0xffff
    buffer_store_dwordx2 v[4:5], v9, s[40:43], s4 offen sc1
    s_mov_b64 exec, -1
L_dgo:
    s_mul_i32 s5, s44, 16384
    s_add_u32 s5, s5, 65536
    v_add_u32 v254, s5, v32
    v_xor_b32 v33, 64, v254
    ds_read_b32 v26, v7 offset:176
    s_waitcnt lgkmcnt(0)
    v_cmp_eq_u32 vcc, 0, v26
    s_nop 0
    s_cbranch_vccnz L_ls_149
L_lb_150:
    s_waitcnt vmcnt(15)
    v_mfma_f32_32x32x16_bf16 v[148:163], v[56:59], v[84:87], 0
    ds_read_b64_tr_b16 v[76:77], v254 offset:0
    buffer_load_dwordx2 v[24:25], v35, s[40:43], 0 offen offset:128 sc1
    s_add_u32 s3, s82, 73728
    buffer_load_dwordx4 v[212:215], v2, s[40:43], s3 offen sc1
    v_mfma_f32_32x32x16_bf16 v[132:147], v[52:55], v[84:87], 0
    ds_read_b64_tr_b16 v[78:79], v254 offset:512
    s_add_u32 s3, s81, 73728
    buffer_load_dwordx4 v[216:219], v2, s[40:43], s3 offen sc1
    s_waitcnt vmcnt(17)
    v_mfma_f32_32x32x16_bf16 v[116:131], v[56:59], v[88:91], 0
    ds_read_b64_tr_b16 v[80:81], v33 offset:0
    s_add_u32 s3, s82, 86016
    buffer_load_dwordx4 v[220:223], v34, s[40:43], s3 offen sc1
    v_mfma_f32_32x32x16_bf16 v[36:51], v[52:55], v[88:91], v[36:51]
    ds_read_b64_tr_b16 v[82:83], v33 offset:512
    s_add_u32 s3, s81, 86016
    buffer_load_dwordx4 v[224:227], v34, s[40:43], s3 offen sc1
    s_xor_b32 s5, s44, 1
    s_lshl_b32 s5, s5, 14
    s_add_u32 s5, s5, 65536
    v_add_u32 v244, s5, v2
    s_waitcnt vmcnt(18)
    v_mfma_f32_32x32x16_bf16 v[148:163], v[64:67], v[92:95], v[148:163]
    ds_read_b64_tr_b16 v[52:53], v254 offset:2048
    v_mfma_f32_32x32x16_bf16 v[132:147], v[60:63], v[92:95], v[132:147]
    ds_read_b64_tr_b16 v[54:55], v254 offset:2560
    s_xor_b32 s5, s44, 2
    s_lshl_b32 s5, s5, 14
    s_add_u32 s5, s5, 69632
    v_add_u32 v245, s5, v2
    s_waitcnt vmcnt(17)
    v_mfma_f32_32x32x16_bf16 v[116:131], v[64:67], v[96:99], v[116:131]
    ds_read_b64_tr_b16 v[56:57], v33 offset:2048
    v_mfma_f32_32x32x16_bf16 v[36:51], v[60:63], v[96:99], v[36:51]
    ds_read_b64_tr_b16 v[58:59], v33 offset:2560
    s_xor_b32 s5, s44, 3
    s_lshl_b32 s5, s5, 14
    s_add_u32 s5, s5, 73728
    v_add_u32 v246, s5, v2
    s_waitcnt vmcnt(16)
    v_mfma_f32_32x32x16_bf16 v[148:163], v[72:75], v[100:103], v[148:163]
    ds_read_b64_tr_b16 v[60:61], v254 offset:4096
    v_mfma_f32_32x32x16_bf16 v[132:147], v[68:71], v[100:103], v[132:147]
    ds_read_b64_tr_b16 v[62:63], v254 offset:4608
    s_lshl_b32 s5, s44, 14
    s_add_u32 s5, s5, 65536
    v_add_u32 v247, s5, v2
    s_waitcnt vmcnt(15)
    v_mfma_f32_32x32x16_bf16 v[116:131], v[72:75], v[104:107], v[116:131]
    ds_read_b64_tr_b16 v[64:65], v33 offset:4096
    s_waitcnt vmcnt(6)
    s_mov_b64 exec, 1
    buffer_store_dwordx2 v[4:5], v10, s[40:43], s89 offen offset:256
    s_mov_b64 exec, -1
    s_lshl_b32 s4, s89, 4
    s_add_u32 s4, s4, 4125102080
    s_mov_b64 exec, 0xffff
    buffer_store_dwordx2 v[4:5], v9, s[40:43], s4 offen sc1
    s_mov_b64 exec, -1
    v_mfma_f32_32x32x16_bf16 v[36:51], v[68:71], v[104:107], v[36:51]
    ds_read_b64_tr_b16 v[66:67], v33 offset:4608
    s_waitcnt lgkmcnt(8)
    v_mfma_f32_32x32x16_bf16 v[148:163], v[80:83], v[108:111], v[148:163]
    ds_read_b64_tr_b16 v[68:69], v254 offset:6144
    s_waitcnt vmcnt(6)
    v_cmp_ne_u64 vcc, s[70:71], v[24:25]
    s_nop 0
    s_cbranch_vccnz L_as_158
L_ab_159:
    s_add_u32 s3, s82, 2048
    buffer_load_dwordx4 v[20:23], v2, s[40:43], s3 offen sc1
    v_mfma_f32_32x32x16_bf16 v[132:147], v[76:79], v[108:111], v[132:147]
    ds_read_b64_tr_b16 v[70:71], v254 offset:6656
    s_add_u32 s3, s81, 2048
    buffer_load_dwordx4 v[28:31], v2, s[40:43], s3 offen sc1
    v_mfma_f32_32x32x16_bf16 v[116:131], v[80:83], v[112:115], v[116:131]
    ds_read_b64_tr_b16 v[72:73], v33 offset:6144
    s_add_u32 s3, s82, 14336
    buffer_load_dwordx4 v[228:231], v2, s[40:43], s3 offen sc1
    v_mfma_f32_32x32x16_bf16 v[36:51], v[76:79], v[112:115], v[36:51]
    ds_read_b64_tr_b16 v[74:75], v33 offset:6656
    s_add_u32 s3, s81, 14336
    buffer_load_dwordx4 v[232:235], v2, s[40:43], s3 offen sc1
    s_waitcnt lgkmcnt(8)
    v_mfma_f32_32x32x16_bf16 v[148:163], v[56:59], v[196:199], v[148:163]
    ds_read_b64_tr_b16 v[76:77], v254 offset:8192
    s_add_u32 s3, s82, 26624
    buffer_load_dwordx4 v[236:239], v2, s[40:43], s3 offen sc1
    v_mfma_f32_32x32x16_bf16 v[132:147], v[52:55], v[196:199], v[132:147]
    ds_read_b64_tr_b16 v[78:79], v254 offset:8704
    s_add_u32 s3, s81, 26624
    buffer_load_dwordx4 v[240:243], v2, s[40:43], s3 offen sc1
    v_mfma_f32_32x32x16_bf16 v[116:131], v[56:59], v[200:203], v[116:131]
    ds_read_b64_tr_b16 v[80:81], v33 offset:8192
    s_add_u32 s3, s82, 38912
    buffer_load_dwordx4 v[84:87], v2, s[40:43], s3 offen sc1
    v_mfma_f32_32x32x16_bf16 v[36:51], v[52:55], v[200:203], v[36:51]
    ds_read_b64_tr_b16 v[82:83], v33 offset:8704
    s_add_u32 s3, s81, 38912
    buffer_load_dwordx4 v[88:91], v2, s[40:43], s3 offen sc1
    s_waitcnt lgkmcnt(8)
    v_mfma_f32_32x32x16_bf16 v[148:163], v[64:67], v[204:207], v[148:163]
    ds_read_b64_tr_b16 v[52:53], v254 offset:10240
    s_add_u32 s3, s82, 51200
    buffer_load_dwordx4 v[92:95], v2, s[40:43], s3 offen sc1
    v_mfma_f32_32x32x16_bf16 v[132:147], v[60:63], v[204:207], v[132:147]
    ds_read_b64_tr_b16 v[54:55], v254 offset:10752
    v_mfma_f32_32x32x16_bf16 v[116:131], v[64:67], v[208:211], v[116:131]
    ds_read_b64_tr_b16 v[56:57], v33 offset:10240
    s_add_u32 s3, s81, 51200
    buffer_load_dwordx4 v[96:99], v2, s[40:43], s3 offen sc1
    v_mfma_f32_32x32x16_bf16 v[36:51], v[60:63], v[208:211], v[36:51]
    ds_read_b64_tr_b16 v[58:59], v33 offset:10752
    s_waitcnt vmcnt(15) lgkmcnt(8)
    v_mfma_f32_32x32x16_bf16 v[148:163], v[72:75], v[212:215], v[148:163]
    ds_read_b64_tr_b16 v[60:61], v254 offset:12288
    s_add_u32 s3, s82, 63488
    buffer_load_dwordx4 v[100:103], v2, s[40:43], s3 offen sc1
    v_mfma_f32_32x32x16_bf16 v[132:147], v[68:71], v[212:215], v[132:147]
    ds_read_b64_tr_b16 v[62:63], v254 offset:12800
    s_waitcnt vmcnt(15)
    v_mfma_f32_32x32x16_bf16 v[116:131], v[72:75], v[216:219], v[116:131]
    s_mul_i32 s5, s44, 16384
    s_add_u32 s5, s5, 0
    v_add_u32 v255, s5, v32
    v_xor_b32 v11, 64, v255
    ds_read_b64_tr_b16 v[64:65], v33 offset:12288
    s_add_u32 s3, s81, 63488
    buffer_load_dwordx4 v[104:107], v2, s[40:43], s3 offen sc1
    v_mfma_f32_32x32x16_bf16 v[36:51], v[68:71], v[216:219], v[36:51]
    ds_read_b64_tr_b16 v[66:67], v33 offset:12800
    s_waitcnt vmcnt(15) lgkmcnt(8)
    v_mfma_f32_32x32x16_bf16 v[148:163], v[80:83], v[220:223], v[148:163]
    ds_read_b32 v26, v7 offset:192
    ds_read_b64_tr_b16 v[68:69], v254 offset:14336
    s_add_u32 s3, s82, 75776
    buffer_load_dwordx4 v[108:111], v2, s[40:43], s3 offen sc1
    v_mfma_f32_32x32x16_bf16 v[132:147], v[76:79], v[220:223], v[132:147]
    ds_read_b64_tr_b16 v[70:71], v254 offset:14848
    s_waitcnt vmcnt(15)
    v_mfma_f32_32x32x16_bf16 v[116:131], v[80:83], v[224:227], v[116:131]
    ds_read_b64_tr_b16 v[72:73], v33 offset:14336
    s_add_u32 s3, s81, 75776
    buffer_load_dwordx4 v[112:115], v2, s[40:43], s3 offen sc1
    v_mfma_f32_32x32x16_bf16 v[36:51], v[76:79], v[224:227], v[36:51]
    s_waitcnt lgkmcnt(3)
    v_cmp_eq_u32 vcc, 0, v26
    s_nop 0
    s_cbranch_vccnz L_ls_152
L_lb_153:
    ds_read_b64_tr_b16 v[74:75], v33 offset:14848
    s_waitcnt vmcnt(13)
    v_mfma_f32_32x32x16_bf16 v[148:163], v[56:59], v[20:23], v[148:163]
    ds_read_b64_tr_b16 v[76:77], v255 offset:0
    v_mfma_f32_32x32x16_bf16 v[132:147], v[52:55], v[20:23], v[132:147]
    ds_read_b64_tr_b16 v[78:79], v255 offset:512
    s_waitcnt vmcnt(12)
    v_mfma_f32_32x32x16_bf16 v[116:131], v[56:59], v[28:31], v[116:131]
    ds_read_b64_tr_b16 v[80:81], v11 offset:0
    v_mfma_f32_32x32x16_bf16 v[36:51], v[52:55], v[28:31], v[36:51]
    ds_read_b64_tr_b16 v[82:83], v11 offset:512
    s_waitcnt vmcnt(11)
    v_mfma_f32_32x32x16_bf16 v[148:163], v[64:67], v[228:231], v[148:163]
    ds_read_b64_tr_b16 v[52:53], v255 offset:2048
    v_mfma_f32_32x32x16_bf16 v[132:147], v[60:63], v[228:231], v[132:147]
    ds_read_b64_tr_b16 v[54:55], v255 offset:2560
    s_waitcnt vmcnt(10)
    v_mfma_f32_32x32x16_bf16 v[116:131], v[64:67], v[232:235], v[116:131]
    ds_read_b64_tr_b16 v[56:57], v11 offset:2048
    v_mfma_f32_32x32x16_bf16 v[36:51], v[60:63], v[232:235], v[36:51]
    ds_read_b64_tr_b16 v[58:59], v11 offset:2560
    s_waitcnt vmcnt(9) lgkmcnt(8)
    v_mfma_f32_32x32x16_bf16 v[148:163], v[72:75], v[236:239], v[148:163]
    ds_read_b64_tr_b16 v[60:61], v255 offset:4096
    buffer_load_dwordx2 v[24:25], v35, s[40:43], 0 offen offset:256 sc1
    v_mfma_f32_32x32x16_bf16 v[132:147], v[68:71], v[236:239], v[132:147]
    ds_read_b64_tr_b16 v[62:63], v255 offset:4608
    s_waitcnt vmcnt(9)
    v_mfma_f32_32x32x16_bf16 v[116:131], v[72:75], v[240:243], v[116:131]
    ds_read_b64_tr_b16 v[64:65], v11 offset:4096
    v_mfma_f32_32x32x16_bf16 v[36:51], v[68:71], v[240:243], v[36:51]
    ds_read_b64_tr_b16 v[66:67], v11 offset:4608
    s_waitcnt vmcnt(8) lgkmcnt(8)
    v_mfma_f32_32x32x16_bf16 v[148:163], v[80:83], v[84:87], v[148:163]
    ds_read_b64_tr_b16 v[68:69], v255 offset:6144
    v_mfma_f32_32x32x16_bf16 v[132:147], v[76:79], v[84:87], v[132:147]
    ds_read_b64_tr_b16 v[70:71], v255 offset:6656
    s_waitcnt vmcnt(7)
    v_mfma_f32_32x32x16_bf16 v[116:131], v[80:83], v[88:91], v[116:131]
    ds_read_b64_tr_b16 v[72:73], v11 offset:6144
    s_waitcnt vmcnt(0)
    v_cmp_ne_u64 vcc, s[70:71], v[24:25]
    s_nop 0
    s_cbranch_vccnz L_as_164
L_ab_165:
    s_add_u32 s3, s82, 4096
    buffer_load_dwordx4 v[196:199], v2, s[40:43], s3 offen sc1
    v_mfma_f32_32x32x16_bf16 v[36:51], v[76:79], v[88:91], v[36:51]
    ds_read_b64_tr_b16 v[74:75], v11 offset:6656
    s_waitcnt lgkmcnt(8)
    v_mfma_f32_32x32x16_bf16 v[148:163], v[56:59], v[92:95], v[148:163]
    ds_read_b64_tr_b16 v[76:77], v255 offset:8192
    s_add_u32 s3, s81, 4096
    buffer_load_dwordx4 v[200:203], v2, s[40:43], s3 offen sc1
    v_mfma_f32_32x32x16_bf16 v[132:147], v[52:55], v[92:95], v[132:147]
    ds_read_b64_tr_b16 v[78:79], v255 offset:8704
    v_mfma_f32_32x32x16_bf16 v[116:131], v[56:59], v[96:99], v[116:131]
    ds_read_b64_tr_b16 v[80:81], v11 offset:8192
    s_add_u32 s3, s82, 16384
    buffer_load_dwordx4 v[204:207], v2, s[40:43], s3 offen sc1
    v_mfma_f32_32x32x16_bf16 v[36:51], v[52:55], v[96:99], v[36:51]
    ds_read_b64_tr_b16 v[82:83], v11 offset:8704
    s_waitcnt lgkmcnt(8)
    v_mfma_f32_32x32x16_bf16 v[148:163], v[64:67], v[100:103], v[148:163]
    ds_read_b64_tr_b16 v[52:53], v255 offset:10240
    s_add_u32 s3, s81, 16384
    buffer_load_dwordx4 v[208:211], v2, s[40:43], s3 offen sc1
    v_mfma_f32_32x32x16_bf16 v[132:147], v[60:63], v[100:103], v[132:147]
    ds_read_b64_tr_b16 v[54:55], v255 offset:10752
    v_mfma_f32_32x32x16_bf16 v[116:131], v[64:67], v[104:107], v[116:131]
    ds_read_b64_tr_b16 v[56:57], v11 offset:10240
    s_add_u32 s3, s82, 28672
    buffer_load_dwordx4 v[212:215], v2, s[40:43], s3 offen sc1
    v_mfma_f32_32x32x16_bf16 v[36:51], v[60:63], v[104:107], v[36:51]
    ds_read_b64_tr_b16 v[58:59], v11 offset:10752
    s_waitcnt lgkmcnt(8)
    v_mfma_f32_32x32x16_bf16 v[148:163], v[72:75], v[108:111], v[148:163]
    ds_read_b64_tr_b16 v[60:61], v255 offset:12288
    s_add_u32 s3, s81, 28672
    buffer_load_dwordx4 v[216:219], v2, s[40:43], s3 offen sc1
    v_mfma_f32_32x32x16_bf16 v[132:147], v[68:71], v[108:111], v[132:147]
    ds_read_b64_tr_b16 v[62:63], v255 offset:12800
    v_mfma_f32_32x32x16_bf16 v[116:131], v[72:75], v[112:115], v[116:131]
    s_mul_i32 s5, s44, 6144
    s_add_u32 s5, s5, 131072
    v_add_u32 v254, s5, v32
    v_xor_b32 v33, 64, v254
    ds_read_b64_tr_b16 v[64:65], v11 offset:12288
    s_add_u32 s3, s82, 40960
    buffer_load_dwordx4 v[220:223], v2, s[40:43], s3 offen sc1
    v_mfma_f32_32x32x16_bf16 v[36:51], v[68:71], v[112:115], v[36:51]
    ds_read_b64_tr_b16 v[66:67], v11 offset:12800
    s_waitcnt vmcnt(6) lgkmcnt(8)
    v_mfma_f32_32x32x16_bf16 v[148:163], v[80:83], v[196:199], v[148:163]
    ds_read_b32 v26, v7 offset:208
    ds_read_b64_tr_b16 v[68:69], v255 offset:14336
    s_add_u32 s3, s81, 40960
    buffer_load_dwordx4 v[224:227], v2, s[40:43], s3 offen sc1
    v_mfma_f32_32x32x16_bf16 v[132:147], v[76:79], v[196:199], v[132:147]
    ds_read_b64_tr_b16 v[70:71], v255 offset:14848
    s_waitcnt vmcnt(6)
    v_mfma_f32_32x32x16_bf16 v[116:131], v[80:83], v[200:203], v[116:131]
    ds_read_b64_tr_b16 v[72:73], v11 offset:14336
    s_add_u32 s3, s82, 53248
    buffer_load_dwordx4 v[20:23], v2, s[40:43], s3 offen sc1
    v_mfma_f32_32x32x16_bf16 v[36:51], v[76:79], v[200:203], v[36:51]
    s_waitcnt lgkmcnt(3)
    v_cmp_eq_u32 vcc, 0, v26
    s_nop 0
    s_cbranch_vccnz L_ls_155
L_lb_156:
    ds_read_b64_tr_b16 v[74:75], v11 offset:14848
    s_waitcnt vmcnt(6)
    v_mfma_f32_32x32x16_bf16 v[148:163], v[56:59], v[204:207], v[148:163]
    ds_read_b64_tr_b16 v[76:77], v254 offset:0
    s_add_u32 s3, s81, 53248
    buffer_load_dwordx4 v[28:31], v2, s[40:43], s3 offen sc1
    v_mfma_f32_32x32x16_bf16 v[132:147], v[52:55], v[204:207], v[132:147]
    ds_read_b64_tr_b16 v[78:79], v254 offset:512
    s_waitcnt vmcnt(6)
    v_mfma_f32_32x32x16_bf16 v[116:131], v[56:59], v[208:211], v[116:131]
    ds_read_b64_tr_b16 v[80:81], v33 offset:0
    s_add_u32 s3, s82, 65536
    buffer_load_dwordx4 v[228:231], v2, s[40:43], s3 offen sc1
    v_mfma_f32_32x32x16_bf16 v[36:51], v[52:55], v[208:211], v[36:51]
    ds_read_b64_tr_b16 v[82:83], v33 offset:512
    s_waitcnt vmcnt(6)
    v_mfma_f32_32x32x16_bf16 v[148:163], v[64:67], v[212:215], v[148:163]
    ds_read_b64_tr_b16 v[52:53], v254 offset:2048
    s_add_u32 s3, s81, 65536
    buffer_load_dwordx4 v[232:235], v2, s[40:43], s3 offen sc1
    v_mfma_f32_32x32x16_bf16 v[132:147], v[60:63], v[212:215], v[132:147]
    ds_read_b64_tr_b16 v[54:55], v254 offset:2560
    s_waitcnt vmcnt(6)
    v_mfma_f32_32x32x16_bf16 v[116:131], v[64:67], v[216:219], v[116:131]
    ds_read_b64_tr_b16 v[56:57], v33 offset:2048
    s_add_u32 s3, s82, 77824
    buffer_load_dwordx4 v[236:239], v2, s[40:43], s3 offen sc1
    s_barrier
    v_mfma_f32_32x32x16_bf16 v[36:51], v[60:63], v[216:219], v[36:51]
    ds_read_b64_tr_b16 v[58:59], v33 offset:2560
    s_waitcnt vmcnt(6) lgkmcnt(8)
    v_mfma_f32_32x32x16_bf16 v[148:163], v[72:75], v[220:223], v[148:163]
    ds_read_b64_tr_b16 v[60:61], v254 offset:4096
    s_add_u32 s3, s81, 77824
    buffer_load_dwordx4 v[240:243], v2, s[40:43], s3 offen sc1
    v_mfma_f32_32x32x16_bf16 v[132:147], v[68:71], v[220:223], v[132:147]
    ds_read_b64_tr_b16 v[62:63], v254 offset:4608
    s_waitcnt vmcnt(6)
    v_mfma_f32_32x32x16_bf16 v[116:131], v[72:75], v[224:227], v[116:131]
    ds_read_b64_tr_b16 v[64:65], v33 offset:4096
    v_mfma_f32_32x32x16_bf16 v[36:51], v[68:71], v[224:227], v[36:51]
    ds_read_b64_tr_b16 v[66:67], v33 offset:4608
    s_waitcnt vmcnt(5) lgkmcnt(8)
    v_mfma_f32_32x32x16_bf16 v[148:163], v[80:83], v[20:23], v[148:163]
    v_mfma_f32_32x32x16_bf16 v[132:147], v[76:79], v[20:23], v[132:147]
    s_waitcnt vmcnt(3) lgkmcnt(4)
    v_mfma_f32_32x32x16_bf16 v[148:163], v[56:59], v[228:231], v[148:163]
    v_mfma_f32_32x32x16_bf16 v[132:147], v[52:55], v[228:231], v[132:147]
    s_waitcnt vmcnt(1) lgkmcnt(0)
    v_mfma_f32_32x32x16_bf16 v[148:163], v[64:67], v[236:239], v[148:163]
    v_mfma_f32_32x32x16_bf16 v[132:147], v[60:63], v[236:239], v[132:147]
    v_mfma_f32_32x32x16_bf16 v[116:131], v[80:83], v[28:31], v[116:131]
    v_mfma_f32_32x32x16_bf16 v[36:51], v[76:79], v[28:31], v[36:51]
    s_nop 8
    ds_write_b128 v246, v[148:151] offset:0
    ds_write_b128 v246, v[152:155] offset:1024
    v_mfma_f32_32x32x16_bf16 v[116:131], v[56:59], v[232:235], v[116:131]
    ds_write_b128 v246, v[156:159] offset:2048
    ds_write_b128 v246, v[160:163] offset:3072
    v_mfma_f32_32x32x16_bf16 v[36:51], v[52:55], v[232:235], v[36:51]
    ds_write_b128 v245, v[132:135] offset:0
    s_waitcnt vmcnt(0)
    v_mfma_f32_32x32x16_bf16 v[116:131], v[64:67], v[240:243], v[116:131]
    ds_write_b128 v245, v[136:139] offset:1024
    ds_write_b128 v245, v[140:143] offset:2048
    v_mfma_f32_32x32x16_bf16 v[36:51], v[60:63], v[240:243], v[36:51]
    ds_write_b128 v245, v[144:147] offset:3072
    s_nop 7
    ds_write_b128 v244, v[116:119] offset:0
    ds_write_b128 v244, v[120:123] offset:1024
    ds_write_b128 v244, v[124:127] offset:2048
    ds_write_b128 v244, v[128:131] offset:3072
    s_waitcnt lgkmcnt(0)
    s_barrier
    ds_read_b128 v[164:167], v247 offset:0
    ds_read_b128 v[168:171], v247 offset:1024
    ds_read_b128 v[172:175], v247 offset:2048
    ds_read_b128 v[176:179], v247 offset:3072
    ds_read_b128 v[180:183], v247 offset:4096
    ds_read_b128 v[184:187], v247 offset:5120
    ds_read_b128 v[188:191], v247 offset:6144
    ds_read_b128 v[192:195], v247 offset:7168
    ds_read_b128 v[196:199], v247 offset:8192
    ds_read_b128 v[200:203], v247 offset:9216
    ds_read_b128 v[204:207], v247 offset:10240
    ds_read_b128 v[208:211], v247 offset:11264
    s_waitcnt lgkmcnt(11)
    v_pk_add_f32 v[36:37], v[36:37], v[164:165]
    v_pk_add_f32 v[38:39], v[38:39], v[166:167]
    s_waitcnt lgkmcnt(10)
    v_pk_add_f32 v[40:41], v[40:41], v[168:169]
    v_pk_add_f32 v[42:43], v[42:43], v[170:171]
    s_waitcnt lgkmcnt(9)
    v_pk_add_f32 v[44:45], v[44:45], v[172:173]
    v_pk_add_f32 v[46:47], v[46:47], v[174:175]
    s_waitcnt lgkmcnt(8)
    v_pk_add_f32 v[48:49], v[48:49], v[176:177]
    v_pk_add_f32 v[50:51], v[50:51], v[178:179]
    s_waitcnt lgkmcnt(7)
    v_pk_add_f32 v[36:37], v[36:37], v[180:181]
    v_pk_add_f32 v[38:39], v[38:39], v[182:183]
    s_waitcnt lgkmcnt(6)
    v_pk_add_f32 v[40:41], v[40:41], v[184:185]
    v_pk_add_f32 v[42:43], v[42:43], v[186:187]
    s_waitcnt lgkmcnt(5)
    v_pk_add_f32 v[44:45], v[44:45], v[188:189]
    v_pk_add_f32 v[46:47], v[46:47], v[190:191]
    s_waitcnt lgkmcnt(4)
    v_pk_add_f32 v[48:49], v[48:49], v[192:193]
    v_pk_add_f32 v[50:51], v[50:51], v[194:195]
    s_waitcnt lgkmcnt(3)
    v_pk_add_f32 v[36:37], v[36:37], v[196:197]
    v_pk_add_f32 v[38:39], v[38:39], v[198:199]
    s_waitcnt lgkmcnt(2)
    v_pk_add_f32 v[40:41], v[40:41], v[200:201]
    v_pk_add_f32 v[42:43], v[42:43], v[202:203]
    s_waitcnt lgkmcnt(1)
    v_pk_add_f32 v[44:45], v[44:45], v[204:205]
    v_pk_add_f32 v[46:47], v[46:47], v[206:207]
    s_waitcnt lgkmcnt(0)
    v_pk_add_f32 v[48:49], v[48:49], v[208:209]
    v_pk_add_f32 v[50:51], v[50:51], v[210:211]
    v_cvt_pk_bf16_f32 v12, v36, v37
    v_cvt_pk_bf16_f32 v13, v38, v39
    v_cvt_pk_bf16_f32 v14, v40, v41
    v_cvt_pk_bf16_f32 v15, v42, v43
    v_cvt_pk_bf16_f32 v16, v44, v45
    v_cvt_pk_bf16_f32 v17, v46, v47
    v_cvt_pk_bf16_f32 v18, v48, v49
    v_cvt_pk_bf16_f32 v19, v50, v51
    buffer_store_dwordx4 v[12:15], v27, s[32:35], 0 offen
    buffer_store_dwordx4 v[16:19], v27, s[32:35], 0 offen offset:32
    s_nop 1
L_end:
    s_endpgm
L_ls_1:
    s_mov_b32 s53, 0
    s_nop 0
L_ll_3:
    ds_read_b32 v13, v8 offset:496
    s_add_u32 s53, s53, 1
    s_sleep 1
    s_waitcnt lgkmcnt(0)
    s_cmp_gt_u32 s53, 1048576
    s_cbranch_scc1 L_lb_2
    v_cmp_eq_u32 vcc, 0, v13
    s_nop 0
    s_cbranch_vccnz L_ll_3
    s_nop 2
    s_branch L_lb_2
L_ls_4:
    s_mov_b32 s53, 0
    s_nop 0
L_ll_6:
    ds_read_b32 v13, v8 offset:512
    s_add_u32 s53, s53, 1
    s_sleep 1
    s_waitcnt lgkmcnt(0)
    s_cmp_gt_u32 s53, 1048576
    s_cbranch_scc1 L_lb_5
    v_cmp_eq_u32 vcc, 0, v13
    s_nop 0
    s_cbranch_vccnz L_ll_6
    s_nop 2
    s_branch L_lb_5
L_ls_7:
    s_mov_b32 s53, 0
    s_nop 0
L_ll_9:
    ds_read_b32 v13, v8 offset:528
    s_add_u32 s53, s53, 1
    s_sleep 1
    s_waitcnt lgkmcnt(0)
    s_cmp_gt_u32 s53, 1048576
    s_cbranch_scc1 L_lb_8
    v_cmp_eq_u32 vcc, 0, v13
    s_nop 0
    s_cbranch_vccnz L_ll_9
    s_nop 2
    s_branch L_lb_8
L_ls_10:
    s_mov_b32 s53, 0
    s_nop 0
L_ll_12:
    ds_read_b32 v13, v8 offset:544
    s_add_u32 s53, s53, 1
    s_sleep 1
    s_waitcnt lgkmcnt(0)
    s_cmp_gt_u32 s53, 1048576
    s_cbranch_scc1 L_lb_11
    v_cmp_eq_u32 vcc, 0, v13
    s_nop 0
    s_cbranch_vccnz L_ll_12
    s_nop 2
    s_branch L_lb_11
L_as_29:
    s_mov_b32 s53, 0
    s_nop 0
L_al_31:
    buffer_load_dwordx2 v[26:27], v20, s[40:43], 0 offen offset:0 sc1
    s_add_u32 s53, s53, 1
    s_waitcnt vmcnt(0)
    s_sleep 1
    s_cmp_gt_u32 s53, 65536
    s_cbranch_scc1 L_ab_30
    v_cmp_ne_u64 vcc, s[70:71], v[26:27]
    s_nop 0
    s_cbranch_vccnz L_al_31
    s_nop 2
    s_branch L_ab_30
L_pubnonce:
    s_or_b32 s100, s100, 1
    v_mov_b32 v4, s100
    v_mov_b32 v5, s101
    s_mov_b64 exec, 1
    buffer_store_dwordx2 v[4:5], v10, s[36:39], 0 offen sc1
    s_mov_b64 exec, -1
    s_nop 0
    s_branch L_pubdone
L_ls_50:
    s_mov_b32 s53, 0
    s_nop 0
L_ll_52:
    ds_read_b32 v58, v8 offset:368
    s_add_u32 s53, s53, 1
    s_waitcnt lgkmcnt(0)
    s_cmp_gt_u32 s53, 1048576
    s_cbranch_scc1 L_lb_51
    v_cmp_eq_u32 vcc, 0, v58
    s_nop 0
    s_cbranch_vccnz L_ll_52
    s_nop 2
    s_branch L_lb_51
L_ls_53:
    s_mov_b32 s53, 0
    s_nop 0
L_ll_55:
    ds_read_b32 v58, v8 offset:656
    s_add_u32 s53, s53, 1
    s_waitcnt lgkmcnt(0)
    s_cmp_gt_u32 s53, 1048576
    s_cbranch_scc1 L_lb_54
    v_cmp_eq_u32 vcc, 0, v58
    s_nop 0
    s_cbranch_vccnz L_ll_55
    s_nop 2
    s_branch L_lb_54
L_ls_56:
    s_mov_b32 s53, 0
    s_nop 0
L_ll_58:
    ds_read_b32 v58, v8 offset:384
    s_add_u32 s53, s53, 1
    s_waitcnt lgkmcnt(0)
    s_cmp_gt_u32 s53, 1048576
    s_cbranch_scc1 L_lb_57
    v_cmp_eq_u32 vcc, 0, v58
    s_nop 0
    s_cbranch_vccnz L_ll_58
    s_nop 2
    s_branch L_lb_57
L_ls_59:
    s_mov_b32 s53, 0
    s_nop 0
L_ll_61:
    ds_read_b32 v58, v8 offset:672
    s_add_u32 s53, s53, 1
    s_waitcnt lgkmcnt(0)
    s_cmp_gt_u32 s53, 1048576
    s_cbranch_scc1 L_lb_60
    v_cmp_eq_u32 vcc, 0, v58
    s_nop 0
    s_cbranch_vccnz L_ll_61
    s_nop 2
    s_branch L_lb_60
L_ls_62:
    s_mov_b32 s53, 0
    s_nop 0
L_ll_64:
    ds_read_b32 v58, v8 offset:400
    s_add_u32 s53, s53, 1
    s_waitcnt lgkmcnt(0)
    s_cmp_gt_u32 s53, 1048576
    s_cbranch_scc1 L_lb_63
    v_cmp_eq_u32 vcc, 0, v58
    s_nop 0
    s_cbranch_vccnz L_ll_64
    s_nop 2
    s_branch L_lb_63
L_ls_65:
    s_mov_b32 s53, 0
    s_nop 0
L_ll_67:
    ds_read_b32 v58, v8 offset:416
    s_add_u32 s53, s53, 1
    s_waitcnt lgkmcnt(0)
    s_cmp_gt_u32 s53, 1048576
    s_cbranch_scc1 L_lb_66
    v_cmp_eq_u32 vcc, 0, v58
    s_nop 0
    s_cbranch_vccnz L_ll_67
    s_nop 2
    s_branch L_lb_66
L_ls_68:
    s_mov_b32 s53, 0
    s_nop 0
L_ll_70:
    ds_read_b32 v58, v8 offset:432
    s_add_u32 s53, s53, 1
    s_waitcnt lgkmcnt(0)
    s_cmp_gt_u32 s53, 1048576
    s_cbranch_scc1 L_lb_69
    v_cmp_eq_u32 vcc, 0, v58
    s_nop 0
    s_cbranch_vccnz L_ll_70
    s_nop 2
    s_branch L_lb_69
L_ls_71:
    s_mov_b32 s53, 0
    s_nop 0
L_ll_73:
    ds_read_b32 v58, v8 offset:448
    s_add_u32 s53, s53, 1
    s_waitcnt lgkmcnt(0)
    s_cmp_gt_u32 s53, 1048576
    s_cbranch_scc1 L_lb_72
    v_cmp_eq_u32 vcc, 0, v58
    s_nop 0
    s_cbranch_vccnz L_ll_73
    s_nop 2
    s_branch L_lb_72
L_ls_74:
    s_mov_b32 s53, 0
    s_nop 0
L_ll_76:
    ds_read_b32 v58, v8 offset:464
    s_add_u32 s53, s53, 1
    s_waitcnt lgkmcnt(0)
    s_cmp_gt_u32 s53, 1048576
    s_cbranch_scc1 L_lb_75
    v_cmp_eq_u32 vcc, 0, v58
    s_nop 0
    s_cbranch_vccnz L_ll_76
    s_nop 2
    s_branch L_lb_75
L_ls_77:
    s_mov_b32 s53, 0
    s_nop 0
L_ll_79:
    ds_read_b32 v58, v8 offset:480
    s_add_u32 s53, s53, 1
    s_waitcnt lgkmcnt(0)
    s_cmp_gt_u32 s53, 1048576
    s_cbranch_scc1 L_lb_78
    v_cmp_eq_u32 vcc, 0, v58
    s_nop 0
    s_cbranch_vccnz L_ll_79
    s_nop 2
    s_branch L_lb_78
L_ls_80:
    s_mov_b32 s53, 0
    s_nop 0
L_ll_82:
    ds_read_b32 v25, v8 offset:256
    s_add_u32 s53, s53, 1
    s_waitcnt lgkmcnt(0)
    s_cmp_gt_u32 s53, 1048576
    s_cbranch_scc1 L_lb_81
    v_cmp_eq_u32 vcc, 0, v25
    s_nop 0
    s_cbranch_vccnz L_ll_82
    s_nop 2
    s_branch L_lb_81
L_ls_83:
    s_mov_b32 s53, 0
    s_nop 0
L_ll_85:
    ds_read_b32 v21, v7 offset:0
    s_add_u32 s53, s53, 1
    s_waitcnt lgkmcnt(0)
    s_cmp_gt_u32 s53, 1048576
    s_cbranch_scc1 L_lb_84
    v_cmp_eq_u32 vcc, 0, v21
    s_nop 0
    s_cbranch_vccnz L_ll_85
    s_nop 2
    s_branch L_lb_84
L_slow_88:
    s_lshl_b32 s4, s76, 4
    s_add_u32 s4, s4, 4125097984
    s_mov_b64 exec, 0xffff
    buffer_store_dwordx2 v[4:5], v9, s[40:43], s4 offen sc1
    s_mov_b64 exec, -1
    s_mov_b32 s53, 0
    v_lshlrev_b32 v30, 4, v33
    v_add_u32 v30, 4125097984, v30
    s_nop 1
L_sl_89:
    buffer_load_dwordx2 v[22:23], v33, s[40:43], 0 offen offset:0 sc1
    buffer_load_dwordx2 v[28:29], v30, s[40:43], 0 offen sc1
    s_add_u32 s53, s53, 1
    s_waitcnt vmcnt(0)
    s_cmp_gt_u32 s53, 65536
    s_cbranch_scc1 L_go_87
    v_cmp_ne_u64 vcc, s[70:71], v[22:23]
    v_cmp_ne_u64 s[6:7], s[70:71], v[28:29]
    s_nop 0
    s_and_b64 vcc, vcc, s[6:7]
    s_cbranch_vccnz L_sl_89
    s_nop 1
    s_branch L_go_87
L_ls_90:
    s_mov_b32 s53, 0
    s_nop 0
L_ll_92:
    ds_read_b32 v21, v8 offset:16
    s_add_u32 s53, s53, 1
    s_waitcnt lgkmcnt(0)
    s_cmp_gt_u32 s53, 1048576
    s_cbranch_scc1 L_lb_91
    v_cmp_eq_u32 vcc, 0, v21
    s_nop 0
    s_cbranch_vccnz L_ll_92
    s_nop 2
    s_branch L_lb_91
L_skipC:
    s_lshl_b32 s4, s85, 4
    s_add_u32 s4, s4, 4125097984
    s_mov_b64 exec, 0xffff
    buffer_store_dwordx2 v[4:5], v9, s[40:43], s4 offen sc1
    s_mov_b64 exec, -1
    ds_write_b32 v6, v6 offset:576
    s_mov_b32 s53, 0
    s_nop 0
L_lw_95:
    ds_read_b32 v26, v8 offset:640
    s_add_u32 s53, s53, 1
    s_cmp_gt_u32 s53, 1048576
    s_cbranch_scc1 L_lg_96
    s_sleep 2
    s_waitcnt lgkmcnt(0)
    v_cmp_eq_u32 vcc, 0, v26
    s_nop 0
    s_cbranch_vccnz L_lw_95
    s_nop 2
L_lg_96:
    ds_write_b32 v6, v6 offset:96
    s_mov_b32 s53, 0
    s_nop 0
L_lw_97:
    ds_read_b32 v26, v8 offset:640
    s_add_u32 s53, s53, 1
    s_cmp_gt_u32 s53, 1048576
    s_cbranch_scc1 L_lg_98
    s_sleep 2
    s_waitcnt lgkmcnt(0)
    v_cmp_eq_u32 vcc, 0, v26
    s_nop 0
    s_cbranch_vccnz L_lw_97
    s_nop 2
L_lg_98:
    ds_write_b32 v6, v6 offset:624
    s_mov_b32 s53, 0
    s_nop 0
L_lw_99:
    ds_read_b32 v26, v8 offset:592
    s_add_u32 s53, s53, 1
    s_cmp_gt_u32 s53, 1048576
    s_cbranch_scc1 L_lg_100
    s_sleep 2
    s_waitcnt lgkmcnt(0)
    v_cmp_eq_u32 vcc, 0, v26
    s_nop 0
    s_cbranch_vccnz L_lw_99
    s_nop 2
L_lg_100:
    ds_write_b32 v6, v6 offset:128
    s_mov_b32 s53, 0
    s_nop 0
L_lw_101:
    ds_read_b32 v26, v8 offset:608
    s_add_u32 s53, s53, 1
    s_cmp_gt_u32 s53, 1048576
    s_cbranch_scc1 L_lg_102
    s_sleep 2
    s_waitcnt lgkmcnt(0)
    v_cmp_eq_u32 vcc, 0, v26
    s_nop 0
    s_cbranch_vccnz L_lw_101
    s_nop 2
L_lg_102:
    ds_write_b32 v6, v6 offset:144
    s_waitcnt vmcnt(0) lgkmcnt(0)
    s_branch L_cdone
L_slow_105:
    s_lshl_b32 s4, s85, 4
    s_add_u32 s4, s4, 4125097984
    s_mov_b64 exec, 0xffff
    buffer_store_dwordx2 v[4:5], v9, s[40:43], s4 offen sc1
    s_mov_b64 exec, -1
    s_mov_b32 s53, 0
    v_lshlrev_b32 v246, 4, v240
    v_add_u32 v246, 4125097984, v246
    s_nop 1
L_sl_106:
    buffer_load_dwordx2 v[24:25], v240, s[40:43], 0 offen offset:0 sc1
    buffer_load_dwordx2 v[244:245], v246, s[40:43], 0 offen sc1
    s_add_u32 s53, s53, 1
    s_waitcnt vmcnt(0)
    s_cmp_gt_u32 s53, 65536
    s_cbranch_scc1 L_go_104
    v_cmp_ne_u64 vcc, s[70:71], v[24:25]
    v_cmp_ne_u64 s[6:7], s[70:71], v[244:245]
    s_nop 0
    s_and_b64 vcc, vcc, s[6:7]
    s_cbranch_vccnz L_sl_106
    s_nop 1
    s_branch L_go_104
L_ls_107:
    s_mov_b32 s53, 0
    s_nop 0
L_ll_109:
    ds_read_b32 v26, v8 offset:64
    s_add_u32 s53, s53, 1
    s_waitcnt lgkmcnt(0)
    s_cmp_gt_u32 s53, 1048576
    s_cbranch_scc1 L_lb_108
    v_cmp_eq_u32 vcc, 0, v26
    s_nop 0
    s_cbranch_vccnz L_ll_109
    s_nop 2
    s_branch L_lb_108
L_ls_110:
    s_mov_b32 s53, 0
    s_nop 0
L_ll_112:
    ds_read_b32 v26, v8 offset:80
    s_add_u32 s53, s53, 1
    s_waitcnt lgkmcnt(0)
    s_cmp_gt_u32 s53, 1048576
    s_cbranch_scc1 L_lb_111
    v_cmp_eq_u32 vcc, 0, v26
    s_nop 0
    s_cbranch_vccnz L_ll_112
    s_nop 2
    s_branch L_lb_111
L_ls_113:
    s_mov_b32 s53, 0
    s_nop 0
L_ll_115:
    ds_read_b32 v26, v8 offset:640
    s_add_u32 s53, s53, 1
    s_waitcnt lgkmcnt(0)
    s_cmp_gt_u32 s53, 1048576
    s_cbranch_scc1 L_lb_114
    v_cmp_eq_u32 vcc, 0, v26
    s_nop 0
    s_cbranch_vccnz L_ll_115
    s_nop 2
    s_branch L_lb_114
L_ls_116:
    s_mov_b32 s53, 0
    s_nop 0
L_ll_118:
    ds_read_b32 v26, v8 offset:592
    s_add_u32 s53, s53, 1
    s_waitcnt lgkmcnt(0)
    s_cmp_gt_u32 s53, 1048576
    s_cbranch_scc1 L_lb_117
    v_cmp_eq_u32 vcc, 0, v26
    s_nop 0
    s_cbranch_vccnz L_ll_118
    s_nop 2
    s_branch L_lb_117
L_ls_119:
    s_mov_b32 s53, 0
    s_nop 0
L_ll_121:
    ds_read_b32 v26, v8 offset:112
    s_add_u32 s53, s53, 1
    s_waitcnt lgkmcnt(0)
    s_cmp_gt_u32 s53, 1048576
    s_cbranch_scc1 L_lb_120
    v_cmp_eq_u32 vcc, 0, v26
    s_nop 0
    s_cbranch_vccnz L_ll_121
    s_nop 2
    s_branch L_lb_120
L_ls_122:
    s_mov_b32 s53, 0
    s_nop 0
L_ll_124:
    ds_read_b32 v26, v8 offset:608
    s_add_u32 s53, s53, 1
    s_waitcnt lgkmcnt(0)
    s_cmp_gt_u32 s53, 1048576
    s_cbranch_scc1 L_lb_123
    v_cmp_eq_u32 vcc, 0, v26
    s_nop 0
    s_cbranch_vccnz L_ll_124
    s_nop 2
    s_branch L_lb_123
L_ls_125:
    s_mov_b32 s53, 0
    s_nop 0
L_ll_127:
    ds_read_b32 v24, v8 offset:288
    s_add_u32 s53, s53, 1
    s_waitcnt lgkmcnt(0)
    s_cmp_gt_u32 s53, 1048576
    s_cbranch_scc1 L_lb_126
    v_cmp_eq_u32 vcc, 0, v24
    s_nop 0
    s_cbranch_vccnz L_ll_127
    s_nop 2
    s_branch L_lb_126
L_slow_132:
    s_lshl_b32 s4, s85, 4
    s_add_u32 s4, s4, 4125097984
    s_mov_b64 exec, 0xffff
    buffer_store_dwordx2 v[4:5], v9, s[40:43], s4 offen sc1
    s_mov_b64 exec, -1
    s_mov_b32 s53, 0
    v_lshlrev_b32 v246, 4, v34
    v_add_u32 v246, 4125097984, v246
    s_nop 1
L_sl_133:
    buffer_load_dwordx2 v[24:25], v34, s[40:43], 0 offen offset:0 sc1
    buffer_load_dwordx2 v[244:245], v246, s[40:43], 0 offen sc1
    s_add_u32 s53, s53, 1
    s_waitcnt vmcnt(0)
    s_cmp_gt_u32 s53, 65536
    s_cbranch_scc1 L_go_131
    v_cmp_ne_u64 vcc, s[70:71], v[24:25]
    v_cmp_ne_u64 s[6:7], s[70:71], v[244:245]
    s_nop 0
    s_and_b64 vcc, vcc, s[6:7]
    s_cbranch_vccnz L_sl_133
    s_nop 1
    s_branch L_go_131
L_as_128:
    s_mov_b32 s52, 0
    s_nop 0
L_poll_130:
    buffer_load_dwordx2 v[24:25], v34, s[40:43], 0 offen offset:0 sc1
    s_add_u32 s52, s52, 1
    s_cmp_gt_u32 s52, 24
    s_cbranch_scc1 L_slow_132
    s_waitcnt vmcnt(0)
    v_cmp_ne_u64 vcc, s[70:71], v[24:25]
    s_nop 0
    s_cbranch_vccnz L_poll_130
    s_nop 2
L_go_131:
    s_branch L_ab_129
L_slow_138:
    s_mov_b32 s53, 0
    v_lshlrev_b32 v78, 4, v35
    v_add_u32 v78, 4125097984, v78
    s_nop 1
L_sl_139:
    buffer_load_dwordx2 v[24:25], v35, s[40:43], 0 offen offset:0 sc1
    buffer_load_dwordx2 v[76:77], v78, s[40:43], 0 offen sc1
    s_add_u32 s53, s53, 1
    s_waitcnt vmcnt(0)
    s_cmp_gt_u32 s53, 65536
    s_cbranch_scc1 L_go_137
    v_cmp_ne_u64 vcc, s[70:71], v[24:25]
    v_cmp_ne_u64 s[6:7], s[70:71], v[76:77]
    s_nop 0
    s_and_b64 vcc, vcc, s[6:7]
    s_cbranch_vccnz L_sl_139
    s_nop 1
    s_branch L_go_137
L_as_134:
    s_mov_b32 s52, 0
    s_nop 0
L_poll_136:
    buffer_load_dwordx2 v[24:25], v35, s[40:43], 0 offen offset:0 sc1
    s_add_u32 s52, s52, 1
    s_cmp_gt_u32 s52, 24
    s_cbranch_scc1 L_slow_138
    s_waitcnt vmcnt(0)
    v_cmp_ne_u64 vcc, s[70:71], v[24:25]
    s_nop 0
    s_cbranch_vccnz L_poll_136
    s_nop 2
L_go_137:
    s_branch L_ab_135
L_ls_140:
    s_mov_b32 s53, 0
    s_nop 0
L_ll_142:
    ds_read_b32 v26, v7 offset:160
    s_add_u32 s53, s53, 1
    s_waitcnt lgkmcnt(0)
    s_cmp_gt_u32 s53, 1048576
    s_cbranch_scc1 L_lb_141
    v_cmp_eq_u32 vcc, 0, v26
    s_nop 0
    s_cbranch_vccnz L_ll_142
    s_nop 2
    s_branch L_lb_141
L_slow_145:
    s_mov_b32 s53, 0
    v_lshlrev_b32 v78, 4, v35
    v_add_u32 v78, 4125097984, v78
    s_nop 1
L_sl_146:
    buffer_load_dwordx2 v[24:25], v35, s[40:43], 0 offen offset:0 sc1
    buffer_load_dwordx2 v[76:77], v78, s[40:43], 0 offen sc1
    s_add_u32 s53, s53, 1
    s_waitcnt vmcnt(0)
    s_cmp_gt_u32 s53, 65536
    s_cbranch_scc1 L_go_144
    v_cmp_ne_u64 vcc, s[70:71], v[24:25]
    v_cmp_ne_u64 s[6:7], s[70:71], v[76:77]
    s_nop 0
    s_and_b64 vcc, vcc, s[6:7]
    s_cbranch_vccnz L_sl_146
    s_nop 1
    s_branch L_go_144
L_cdone:
    s_mov_b32 s52, 0
    s_nop 0
L_poll_143:
    buffer_load_dwordx2 v[24:25], v35, s[40:43], 0 offen offset:0 sc1
    s_add_u32 s52, s52, 1
    s_cmp_gt_u32 s52, 24
    s_cbranch_scc1 L_slow_145
    s_waitcnt vmcnt(0)
    v_cmp_ne_u64 vcc, s[70:71], v[24:25]
    s_nop 0
    s_cbranch_vccnz L_poll_143
    s_nop 2
L_go_144:
    s_mul_i32 s5, s44, 6144
    s_add_u32 s5, s5, 131072
    v_add_u32 v255, s5, v32
    v_xor_b32 v11, 64, v255
    s_cmp_ge_u32 s44, 2
    s_cselect_b32 s5, 0x80000000, 0
    v_or_b32 v34, s5, v2
    s_add_u32 s3, s82, 0
    buffer_load_dwordx4 v[84:87], v2, s[40:43], s3 offen sc1
    s_add_u32 s3, s81, 0
    buffer_load_dwordx4 v[88:91], v2, s[40:43], s3 offen sc1
    s_add_u32 s3, s82, 12288
    buffer_load_dwordx4 v[92:95], v2, s[40:43], s3 offen sc1
    s_add_u32 s3, s81, 12288
    buffer_load_dwordx4 v[96:99], v2, s[40:43], s3 offen sc1
    s_add_u32 s3, s82, 24576
    buffer_load_dwordx4 v[100:103], v2, s[40:43], s3 offen sc1
    s_add_u32 s3, s81, 24576
    buffer_load_dwordx4 v[104:107], v2, s[40:43], s3 offen sc1
    s_add_u32 s3, s82, 36864
    buffer_load_dwordx4 v[108:111], v2, s[40:43], s3 offen sc1
    s_add_u32 s3, s81, 36864
    buffer_load_dwordx4 v[112:115], v2, s[40:43], s3 offen sc1
    s_add_u32 s3, s82, 49152
    buffer_load_dwordx4 v[196:199], v2, s[40:43], s3 offen sc1
    s_add_u32 s3, s81, 49152
    buffer_load_dwordx4 v[200:203], v2, s[40:43], s3 offen sc1
    s_add_u32 s3, s82, 61440
    buffer_load_dwordx4 v[204:207], v2, s[40:43], s3 offen sc1
    s_add_u32 s3, s81, 61440
    buffer_load_dwordx4 v[208:211], v2, s[40:43], s3 offen sc1
    v_lshlrev_b32 v36, 16, v12
    v_and_b32 v37, 0xffff0000, v12
    v_lshlrev_b32 v38, 16, v13
    v_and_b32 v39, 0xffff0000, v13
    v_lshlrev_b32 v40, 16, v14
    v_and_b32 v41, 0xffff0000, v14
    v_lshlrev_b32 v42, 16, v15
    v_and_b32 v43, 0xffff0000, v15
    v_lshlrev_b32 v44, 16, v16
    v_and_b32 v45, 0xffff0000, v16
    v_lshlrev_b32 v46, 16, v17
    v_and_b32 v47, 0xffff0000, v17
    v_lshlrev_b32 v48, 16, v18
    v_and_b32 v49, 0xffff0000, v18
    v_lshlrev_b32 v50, 16, v19
    v_and_b32 v51, 0xffff0000, v19
    s_mov_b32 s53, 0
    s_nop 0
L_lw_147:
    ds_read_b32 v26, v7 offset:160
    s_add_u32 s53, s53, 1
    s_cmp_gt_u32 s53, 1048576
    s_cbranch_scc1 L_lg_148
    s_waitcnt lgkmcnt(0)
    v_cmp_eq_u32 vcc, 0, v26
    s_nop 0
    s_cbranch_vccnz L_lw_147
    s_nop 2
L_lg_148:
    ds_read_b64_tr_b16 v[52:53], v255 offset:0
    ds_read_b64_tr_b16 v[54:55], v255 offset:512
    ds_read_b64_tr_b16 v[56:57], v11 offset:0
    ds_read_b64_tr_b16 v[58:59], v11 offset:512
    ds_read_b64_tr_b16 v[60:61], v255 offset:2048
    ds_read_b64_tr_b16 v[62:63], v255 offset:2560
    ds_read_b64_tr_b16 v[64:65], v11 offset:2048
    ds_read_b64_tr_b16 v[66:67], v11 offset:2560
    ds_read_b64_tr_b16 v[68:69], v255 offset:4096
    ds_read_b64_tr_b16 v[70:71], v255 offset:4608
    ds_read_b64_tr_b16 v[72:73], v11 offset:4096
    ds_read_b64_tr_b16 v[74:75], v11 offset:4608
    ds_write_b32 v6, v6 offset:224
    s_waitcnt vmcnt(0) lgkmcnt(0)
    s_branch L_dgo
L_ls_149:
    s_mov_b32 s53, 0
    s_nop 0
L_ll_151:
    ds_read_b32 v26, v7 offset:176
    s_add_u32 s53, s53, 1
    s_waitcnt lgkmcnt(0)
    s_cmp_gt_u32 s53, 1048576
    s_cbranch_scc1 L_lb_150
    v_cmp_eq_u32 vcc, 0, v26
    s_nop 0
    s_cbranch_vccnz L_ll_151
    s_nop 2
    s_branch L_lb_150
L_ls_152:
    s_mov_b32 s53, 0
    s_nop 0
L_ll_154:
    ds_read_b32 v26, v7 offset:192
    s_add_u32 s53, s53, 1
    s_waitcnt lgkmcnt(0)
    s_cmp_gt_u32 s53, 1048576
    s_cbranch_scc1 L_lb_153
    v_cmp_eq_u32 vcc, 0, v26
    s_nop 0
    s_cbranch_vccnz L_ll_154
    s_nop 2
    s_branch L_lb_153
L_ls_155:
    s_mov_b32 s53, 0
    s_nop 0
L_ll_157:
    ds_read_b32 v26, v7 offset:208
    s_add_u32 s53, s53, 1
    s_waitcnt lgkmcnt(0)
    s_cmp_gt_u32 s53, 1048576
    s_cbranch_scc1 L_lb_156
    v_cmp_eq_u32 vcc, 0, v26
    s_nop 0
    s_cbranch_vccnz L_ll_157
    s_nop 2
    s_branch L_lb_156
L_slow_162:
    s_mov_b32 s53, 0
    v_lshlrev_b32 v14, 4, v35
    v_add_u32 v14, 4125100032, v14
    s_nop 1
L_sl_163:
    buffer_load_dwordx2 v[24:25], v35, s[40:43], 0 offen offset:128 sc1
    buffer_load_dwordx2 v[12:13], v14, s[40:43], 0 offen sc1
    s_add_u32 s53, s53, 1
    s_waitcnt vmcnt(0)
    s_cmp_gt_u32 s53, 65536
    s_cbranch_scc1 L_go_161
    v_cmp_ne_u64 vcc, s[70:71], v[24:25]
    v_cmp_ne_u64 s[6:7], s[70:71], v[12:13]
    s_nop 0
    s_and_b64 vcc, vcc, s[6:7]
    s_cbranch_vccnz L_sl_163
    s_nop 1
    s_branch L_go_161
L_as_158:
    s_mov_b32 s52, 0
    s_nop 0
L_poll_160:
    buffer_load_dwordx2 v[24:25], v35, s[40:43], 0 offen offset:128 sc1
    s_add_u32 s52, s52, 1
    s_cmp_gt_u32 s52, 24
    s_cbranch_scc1 L_slow_162
    s_waitcnt vmcnt(0)
    v_cmp_ne_u64 vcc, s[70:71], v[24:25]
    s_nop 0
    s_cbranch_vccnz L_poll_160
    s_nop 2
L_go_161:
    s_branch L_ab_159
L_slow_168:
    s_mov_b32 s53, 0
    v_lshlrev_b32 v14, 4, v35
    v_add_u32 v14, 4125102080, v14
    s_nop 1
L_sl_169:
    buffer_load_dwordx2 v[24:25], v35, s[40:43], 0 offen offset:256 sc1
    buffer_load_dwordx2 v[12:13], v14, s[40:43], 0 offen sc1
    s_add_u32 s53, s53, 1
    s_waitcnt vmcnt(0)
    s_cmp_gt_u32 s53, 65536
    s_cbranch_scc1 L_go_167
    v_cmp_ne_u64 vcc, s[70:71], v[24:25]
    v_cmp_ne_u64 s[6:7], s[70:71], v[12:13]
    s_nop 0
    s_and_b64 vcc, vcc, s[6:7]
    s_cbranch_vccnz L_sl_169
    s_nop 1
    s_branch L_go_167
L_as_164:
    s_mov_b32 s52, 0
    s_nop 0
L_poll_166:
    buffer_load_dwordx2 v[24:25], v35, s[40:43], 0 offen offset:256 sc1
    s_add_u32 s52, s52, 1
    s_cmp_gt_u32 s52, 24
    s_cbranch_scc1 L_slow_168
    s_waitcnt vmcnt(0)
    v_cmp_ne_u64 vcc, s[70:71], v[24:25]
    s_nop 0
    s_cbranch_vccnz L_poll_166
    s_nop 2
L_go_167:
    s_branch L_ab_165
L_codeend:
    s_endpgm
.section .rodata,"a"
.p2align 6
.amdhsa_kernel sequential_preLN__sliding_local_dilated__glu_gated_geglu__prompt_kernel
  .amdhsa_next_free_vgpr 256
  .amdhsa_next_free_sgpr 102
  .amdhsa_accum_offset 256
  .amdhsa_group_segment_fixed_size 0
  .amdhsa_kernarg_size 80
  .amdhsa_user_sgpr_count 2
  .amdhsa_user_sgpr_kernarg_segment_ptr 1
  .amdhsa_system_sgpr_workgroup_id_x 1
  .amdhsa_float_denorm_mode_32 3
.end_amdhsa_kernel
```
